```python
import torch

def _softmax(x, axis=-1):
    return torch.softmax(x, dim=axis)
def _gelu(x):
    return torch.nn.functional.gelu(x, approximate="tanh")
def _silu(x):
    return torch.nn.functional.silu(x)
def _sigmoid(x):
    return torch.sigmoid(x)
def _layernorm(x, axis=-1, eps=1e-5):
    m = x.mean(dim=axis, keepdim=True)
    v = x.var(dim=axis, keepdim=True, unbiased=False)
    return (x - m) / torch.sqrt(v + eps)
def _scatter_add(tgt, idx, src, axis=0):
    return tgt.clone().index_add_(axis, idx, src)
def _segment_sum(src, seg, n):
    out = torch.zeros((n,) + src.shape[1:], dtype=src.dtype)
    return out.index_add_(0, seg, src)
def _pad(x, pw):
    flat = tuple(v for pair in reversed(pw) for v in pair)
    return torch.nn.functional.pad(x, flat)

kernel_name = 'recurrent_scan__sliding_block_cached__glu_gated_swiglu__decode'

def setup_inputs():

    _w = (lambda a: (lambda t: t.to(torch.bfloat16) if t.is_floating_point() else t)(torch.as_tensor(a)))
    def _A_setup():
        B, Sq, D = 1, 1, 576
        Hq, Hkv, Sk, Dh = 32, 16, 65536, 128
        assert Hq % Hkv == 0, (Hq, Hkv)
        return {
            "x": _w((lambda *s: torch.randn(*s, dtype=torch.bfloat16) * 0.05)(B, Sq, D)),
            "k_cache": _w((lambda *s: torch.randn(*s, dtype=torch.bfloat16) * 3.2)(B, Hkv, Sk, Dh)),
            "v_cache": _w((lambda *s: torch.randn(*s, dtype=torch.bfloat16) * 3.2)(B, Hkv, Sk, Dh)),
            "wq": _w((lambda *s: torch.randn(*s, dtype=torch.bfloat16) * 3.2)(D, Hq * Dh) * (D ** -0.5)),
            "wo": _w((lambda *s: torch.randn(*s, dtype=torch.bfloat16) * 3.2)(Hq * Dh, D) * ((Hq * Dh) ** -0.5)),
        }
    _A_in = _A_setup()

    def _B_setup():
        B, S, D, F = 1, 1, 576, 4608
        return {
            "x": _w((lambda *s: torch.randn(*s, dtype=torch.bfloat16) * 0.05)(B, S, D)),
            "w1": _w((lambda *s: torch.randn(*s, dtype=torch.bfloat16) * 0.4)(D, F) * (2.0 / D) ** 0.5),
            "w3": _w((lambda *s: torch.randn(*s, dtype=torch.bfloat16) * 0.4)(D, F) * (2.0 / D) ** 0.5),
            "w2": _w((lambda *s: torch.randn(*s, dtype=torch.bfloat16) * 0.4)(F, D) * (2.0 / F) ** 0.5),
        }
    _B_in = _B_setup()

    return {
        "A_x": _A_in["x"],
        "A_k_cache": _A_in["k_cache"],
        "A_v_cache": _A_in["v_cache"],
        "A_wq": _A_in["wq"],
        "A_wo": _A_in["wo"],
        "B_x": _B_in["x"],
        "B_w1": _B_in["w1"],
        "B_w3": _B_in["w3"],
        "B_w2": _B_in["w2"],
    }

def reference(A_x, A_k_cache, A_v_cache, A_wq, A_wo, B_x, B_w1, B_w3, B_w2):
    def _A_ref(x, k_cache, v_cache, wq, wo):
        B, Sq, D = x.shape
        Hq, Dh = 32, 128
        Hkv, Sk = k_cache.shape[1], k_cache.shape[2]
        W = min(4096, max(256, Sk // 4))
        rep = Hq // Hkv
        q = (lambda x, *d: x.permute(*d))((x @ wq).reshape(B, Sq, Hq, Dh), 0, 2, 1, 3)
        k = (lambda x, n, axis: torch.repeat_interleave(x, n, dim=axis))(k_cache[:, :, Sk - W:, :], rep, axis=1)
        v = (lambda x, n, axis: torch.repeat_interleave(x, n, dim=axis))(v_cache[:, :, Sk - W:, :], rep, axis=1)
        scores = torch.einsum("bhqd,bhkd->bhqk", q, k) * (Dh ** -0.5)
        p = _softmax(scores, axis=-1)
        o = torch.einsum("bhqk,bhkd->bhqd", p, v)
        return (lambda x, *d: x.permute(*d))(o, 0, 2, 1, 3).reshape(B, Sq, Hq * Dh) @ wo

    def _B_ref(x, w1, w3, w2):
        gate = torch.einsum("bsd,df->bsf", x, w1)
        up = torch.einsum("bsd,df->bsf", x, w3)
        h = _silu(gate) * up
        out = torch.einsum("bsf,fd->bsd", h, w2)
        return out

    x = A_x
    xn = _layernorm(x, axis=-1)
    s = _A_ref(xn, A_k_cache, A_v_cache, A_wq, A_wo)
    g = _silu(_B_ref(xn, B_w1, B_w3, B_w2))
    return x + s * g
```

```asm
; @launch grid=(256,1,1) block=(896,1,1) lds=158112
.amdgcn_target "amdgcn-amd-amdhsa--gfx950"
.text
.globl recurrent_scan__sliding_block_cached__glu_gated_swiglu__decode_kernel
.p2align 12
.p2align 8
.type recurrent_scan__sliding_block_cached__glu_gated_swiglu__decode_kernel,@function
recurrent_scan__sliding_block_cached__glu_gated_swiglu__decode_kernel:
    s_load_dwordx16 s[4:19], s[0:1], 0
    s_load_dwordx8 s[20:27], s[0:1], 64
    v_lshrrev_b32 v1, 6, v0
    v_and_b32 v0, 63, v0
    v_readfirstlane_b32 s3, v1
    s_cmp_ge_u32 s2, 256
    s_cbranch_scc1 L_end
    s_and_b32 s28, s2, 7
    s_lshl_b32 s28, s28, 1
    s_bfe_u32 s30, s2, 0x10003
    s_add_u32 s28, s28, s30
    s_lshr_b32 s29, s2, 4
    v_and_b32 v1, 7, v0
    v_lshrrev_b32 v2, 3, v0
    v_mov_b32 v3, 158048
    s_cmp_eq_u32 s3, 0
    s_cbranch_scc1 L_roleL
    s_and_b32 s30, s29, 7
    s_lshl_b32 s31, s28, 3
    s_add_u32 s31, s31, s30
    s_lshl_b32 s74, s28, 4
    s_add_u32 s74, s74, s29
    s_mul_i32 s74, s74, 2944
    s_and_b32 s75, s2, 7
    s_mul_i32 s75, s75, 94208
    s_lshr_b32 s40, s2, 6
    s_lshl_b32 s40, s40, 14
    s_and_b32 s41, s2, 63
    s_lshl_b32 s41, s41, 7
    s_add_u32 s40, s40, s41
    s_add_u32 s40, s40, 835584
    s_and_b32 s66, s28, 1
    s_lshl_b32 s41, s66, 13
    s_add_u32 s40, s40, s41
    s_xor_b32 s41, s40, 0x2000
    s_cmp_lg_u32 s3, 6
    s_cbranch_scc1 L_nopf_1
    s_getpc_b64 s[48:49]
L_pc:
    s_sub_u32 s48, s48, L_pc-recurrent_scan__sliding_block_cached__glu_gated_swiglu__decode_kernel
    s_subb_u32 s49, s49, 0
    s_lshr_b32 s50, s2, 3
    s_lshl_b32 s50, s50, 9
    v_lshl_add_u32 v4, v0, 7, s50
    v_min_u32 v4, L_end-recurrent_scan__sliding_block_cached__glu_gated_swiglu__decode_kernel, v4
    s_mov_b64 exec, 15
    global_load_dword v126, v4, s[48:49]
    s_mov_b64 exec, -1
L_nopf_1:
    s_barrier
    s_cmp_lt_u32 s2, 80
    s_cselect_b32 s33, 4, 99
    s_cmp_eq_u32 s3, s33
    s_cbranch_scc1 L_race
    s_cmp_eq_u32 s3, 1
    s_cbranch_scc1 L_roleQ
    s_cmp_ge_u32 s3, 11
    s_cbranch_scc1 L_roleO
    s_cmp_ge_u32 s3, 6
    s_cbranch_scc1 L_roleF
    s_branch L_roleA
L_race:
    s_waitcnt lgkmcnt(0)
    s_load_dword s70, s[26:27], s40
    s_load_dwordx2 s[72:73], s[26:27], s41
    s_waitcnt lgkmcnt(2)
    s_getreg_b32 s67, hwreg(HW_REG_IB_STS, 8, 4)
    s_cmp_lg_u32 s67, 2
    s_addc_u32 s66, s66, 0
    s_and_b32 s66, s66, 1
L_raced:
    s_add_u32 s66, s66, 1
    v_mov_b32 v6, s66
    ds_write_b32 v3, v6 offset:48
    s_branch L_roleA
L_roleL:
    s_setprio 2
    v_lshlrev_b32 v7, 4, v0
    v_lshrrev_b32 v13, 4, v0
    v_lshlrev_b32 v13, 13, v13
    v_and_b32 v14, 15, v0
    v_lshl_add_u32 v13, v14, 4, v13
    v_lshlrev_b32 v14, 2, v0
    v_add_u32 v15, 31744, v13
    v_add_u32 v16, 63488, v13
    v_add_u32 v17, 95232, v13
    s_lshr_b32 s42, s29, 1
    s_mul_i32 s40, s42, 589824
    s_lshl_b32 s43, s28, 1
    s_and_b32 s42, s29, 1
    s_add_u32 s43, s43, s42
    s_lshl_b32 s43, s43, 8
    s_add_u32 s40, s40, s43
    s_mov_b32 s34, 1152
    s_mov_b32 s35, 0x20000
    s_mov_b32 s38, 4718592
    s_mov_b32 s39, 0x20000
    v_lshrrev_b32 v4, 4, v0
    v_and_b32 v5, 15, v0
    v_xor_b32 v6, v4, v5
    v_lshlrev_b32 v6, 4, v6
    v_lshl_add_u32 v8, v4, 8, v6
    v_xor_b32 v9, 64, v8
    v_xor_b32 v10, 128, v8
    v_xor_b32 v11, 192, v8
    s_lshl_b32 s41, s28, 24
    s_lshl_b32 s46, s29, 16
    s_add_u32 s41, s41, s46
    s_add_u32 s41, s41, 15728640
    s_add_u32 s45, s28, s29
    s_lshl_b32 s45, s45, 12
    s_mov_b32 s56, 0xf000
    s_mov_b32 s50, 0x10000000
    s_mov_b32 s51, 0x20000
    s_mov_b32 s54, 0x10000000
    s_mov_b32 s55, 0x20000
    v_mov_b32 v20, 0
    v_mov_b32 v21, 0
    v_mov_b32 v22, 0
    v_mov_b32 v23, 0
    ds_write_b128 v3, v[20:23] offset:0
    ds_write_b128 v3, v[20:23] offset:16
    ds_write_b128 v3, v[20:23] offset:32
    ds_write_b128 v3, v[20:23] offset:48
    v_add_u32 v24, 157792, v14
    v_mov_b32 v25, -1
    ds_write_b32 v24, v25
    s_mov_b32 m0, 149504
    s_waitcnt lgkmcnt(0)
    s_barrier
    s_mov_b64 s[32:33], s[4:5]
    s_mov_b64 s[36:37], s[10:11]
    buffer_load_dwordx4 v7, s[32:35], 0 offen lds
    buffer_load_dword v14, s[32:35], 0 offen offset:1024 lds
    s_mov_b32 m0, 131072
    s_nop 0
    buffer_load_dwordx4 v13, s[36:39], s40 offen offset:0 nt lds
    buffer_load_dwordx4 v15, s[36:39], s40 offen offset:1024 nt lds
    buffer_load_dwordx4 v16, s[36:39], s40 offen offset:2048 nt lds
    buffer_load_dwordx4 v17, s[36:39], s40 offen offset:3072 nt lds
    s_mov_b32 m0, 135168
    s_add_u32 s40, s40, 131072
    buffer_load_dwordx4 v13, s[36:39], s40 offen offset:0 nt lds
    buffer_load_dwordx4 v15, s[36:39], s40 offen offset:1024 nt lds
    buffer_load_dwordx4 v16, s[36:39], s40 offen offset:2048 nt lds
    buffer_load_dwordx4 v17, s[36:39], s40 offen offset:3072 nt lds
    s_mov_b32 m0, 139264
    s_add_u32 s40, s40, 131072
    buffer_load_dwordx4 v13, s[36:39], s40 offen offset:0 nt lds
    buffer_load_dwordx4 v15, s[36:39], s40 offen offset:1024 nt lds
    buffer_load_dwordx4 v16, s[36:39], s40 offen offset:2048 nt lds
    buffer_load_dwordx4 v17, s[36:39], s40 offen offset:3072 nt lds
    s_mov_b32 m0, 143360
    s_add_u32 s40, s40, 131072
    buffer_load_dwordx4 v13, s[36:39], s40 offen offset:0 nt lds
    buffer_load_dwordx4 v15, s[36:39], s40 offen offset:1024 nt lds
    buffer_load_dwordx4 v16, s[36:39], s40 offen offset:2048 nt lds
    buffer_load_dwordx4 v17, s[36:39], s40 offen offset:3072 nt lds
    s_mov_b32 m0, 147456
    s_add_u32 s40, s40, 131072
    buffer_load_dwordx4 v13, s[36:39], s40 offen offset:0 nt lds
    buffer_load_dwordx4 v15, s[36:39], s40 offen offset:1024 nt lds
    s_mov_b64 s[48:49], s[6:7]
    s_mov_b64 s[52:53], s[8:9]
    s_mov_b32 m0, 0
    s_and_b32 s44, s45, s56
    s_add_u32 s44, s44, s41
    s_addk_i32 s45, 0x1000
    buffer_load_dwordx4 v8, s[48:51], s44 offen offset:0 nt lds
    buffer_load_dwordx4 v9, s[48:51], s44 offen offset:1024 nt lds
    buffer_load_dwordx4 v10, s[48:51], s44 offen offset:2048 nt lds
    buffer_load_dwordx4 v11, s[48:51], s44 offen offset:3072 nt lds
    s_addk_i32 m0, 0x4000
    s_and_b32 s44, s45, s56
    s_add_u32 s44, s44, s41
    s_addk_i32 s45, 0x1000
    buffer_load_dwordx4 v8, s[48:51], s44 offen offset:0 nt lds
    buffer_load_dwordx4 v9, s[48:51], s44 offen offset:1024 nt lds
    buffer_load_dwordx4 v10, s[48:51], s44 offen offset:2048 nt lds
    buffer_load_dwordx4 v11, s[48:51], s44 offen offset:3072 nt lds
    s_addk_i32 m0, 0x4000
    s_and_b32 s44, s45, s56
    s_add_u32 s44, s44, s41
    s_addk_i32 s45, 0x1000
    buffer_load_dwordx4 v8, s[48:51], s44 offen offset:0 nt lds
    buffer_load_dwordx4 v9, s[48:51], s44 offen offset:1024 nt lds
    buffer_load_dwordx4 v10, s[48:51], s44 offen offset:2048 nt lds
    buffer_load_dwordx4 v11, s[48:51], s44 offen offset:3072 nt lds
    s_addk_i32 m0, 0x4000
    s_and_b32 s44, s45, s56
    s_add_u32 s44, s44, s41
    s_addk_i32 s45, 0x1000
    buffer_load_dwordx4 v8, s[48:51], s44 offen offset:0 nt lds
    buffer_load_dwordx4 v9, s[48:51], s44 offen offset:1024 nt lds
    buffer_load_dwordx4 v10, s[48:51], s44 offen offset:2048 nt lds
    buffer_load_dwordx4 v11, s[48:51], s44 offen offset:3072 nt lds
    s_waitcnt vmcnt(34)
    v_mov_b32 v12, 2
    ds_write_b32 v3, v12 offset:32
    s_waitcnt vmcnt(25)
    v_mov_b32 v12, 11
    ds_write_b32 v3, v12 offset:32
    s_waitcnt vmcnt(24)
    s_mov_b32 m0, 4096
    s_and_b32 s44, s45, s56
    s_add_u32 s44, s44, s41
    s_addk_i32 s45, 0x1000
    buffer_load_dwordx4 v8, s[48:51], s44 offen offset:0 nt lds
    buffer_load_dwordx4 v9, s[48:51], s44 offen offset:1024 nt lds
    buffer_load_dwordx4 v10, s[48:51], s44 offen offset:2048 nt lds
    buffer_load_dwordx4 v11, s[48:51], s44 offen offset:3072 nt lds
    s_waitcnt vmcnt(24)
    s_addk_i32 m0, 0x4000
    s_and_b32 s44, s45, s56
    s_add_u32 s44, s44, s41
    s_addk_i32 s45, 0x1000
    buffer_load_dwordx4 v8, s[48:51], s44 offen offset:0 nt lds
    buffer_load_dwordx4 v9, s[48:51], s44 offen offset:1024 nt lds
    buffer_load_dwordx4 v10, s[48:51], s44 offen offset:2048 nt lds
    buffer_load_dwordx4 v11, s[48:51], s44 offen offset:3072 nt lds
    s_waitcnt vmcnt(24)
    v_mov_b32 v12, 20
    ds_write_b32 v3, v12 offset:32
    s_addk_i32 m0, 0x4000
    s_and_b32 s44, s45, s56
    s_add_u32 s44, s44, s41
    s_addk_i32 s45, 0x1000
    buffer_load_dwordx4 v8, s[48:51], s44 offen offset:0 nt lds
    buffer_load_dwordx4 v9, s[48:51], s44 offen offset:1024 nt lds
    buffer_load_dwordx4 v10, s[48:51], s44 offen offset:2048 nt lds
    buffer_load_dwordx4 v11, s[48:51], s44 offen offset:3072 nt lds
    s_waitcnt vmcnt(24)
    v_mov_b32 v12, 24
    ds_write_b32 v3, v12 offset:32
    s_addk_i32 m0, 0x4000
    s_and_b32 s44, s45, s56
    s_add_u32 s44, s44, s41
    s_addk_i32 s45, 0x1000
    buffer_load_dwordx4 v8, s[48:51], s44 offen offset:0 nt lds
    buffer_load_dwordx4 v9, s[48:51], s44 offen offset:1024 nt lds
    buffer_load_dwordx4 v10, s[48:51], s44 offen offset:2048 nt lds
    buffer_load_dwordx4 v11, s[48:51], s44 offen offset:3072 nt lds
    s_waitcnt vmcnt(24)
    v_mov_b32 v12, 28
    ds_write_b32 v3, v12 offset:32
    s_mov_b32 m0, 8192
    s_and_b32 s44, s45, s56
    s_add_u32 s44, s44, s41
    s_addk_i32 s45, 0x1000
    buffer_load_dwordx4 v8, s[48:51], s44 offen offset:0 nt lds
    buffer_load_dwordx4 v9, s[48:51], s44 offen offset:1024 nt lds
    buffer_load_dwordx4 v10, s[48:51], s44 offen offset:2048 nt lds
    buffer_load_dwordx4 v11, s[48:51], s44 offen offset:3072 nt lds
    s_waitcnt vmcnt(24)
    v_mov_b32 v12, 32
    ds_write_b32 v3, v12 offset:32
    s_addk_i32 m0, 0x4000
    s_and_b32 s44, s45, s56
    s_add_u32 s44, s44, s41
    s_addk_i32 s45, 0x1000
    buffer_load_dwordx4 v8, s[48:51], s44 offen offset:0 nt lds
    buffer_load_dwordx4 v9, s[48:51], s44 offen offset:1024 nt lds
    buffer_load_dwordx4 v10, s[48:51], s44 offen offset:2048 nt lds
    buffer_load_dwordx4 v11, s[48:51], s44 offen offset:3072 nt lds
    s_waitcnt vmcnt(24)
    v_mov_b32 v12, 36
    ds_write_b32 v3, v12 offset:32
    s_addk_i32 m0, 0x4000
    s_and_b32 s44, s45, s56
    s_add_u32 s44, s44, s41
    s_addk_i32 s45, 0x1000
    buffer_load_dwordx4 v8, s[48:51], s44 offen offset:0 nt lds
    buffer_load_dwordx4 v9, s[48:51], s44 offen offset:1024 nt lds
    buffer_load_dwordx4 v10, s[48:51], s44 offen offset:2048 nt lds
    buffer_load_dwordx4 v11, s[48:51], s44 offen offset:3072 nt lds
    s_waitcnt vmcnt(24)
    v_mov_b32 v12, 40
    ds_write_b32 v3, v12 offset:32
    s_addk_i32 m0, 0x4000
    s_and_b32 s44, s45, s56
    s_add_u32 s44, s44, s41
    s_addk_i32 s45, 0x1000
    buffer_load_dwordx4 v8, s[48:51], s44 offen offset:0 nt lds
    buffer_load_dwordx4 v9, s[48:51], s44 offen offset:1024 nt lds
    buffer_load_dwordx4 v10, s[48:51], s44 offen offset:2048 nt lds
    buffer_load_dwordx4 v11, s[48:51], s44 offen offset:3072 nt lds
    s_waitcnt vmcnt(24)
    v_mov_b32 v12, 44
    ds_write_b32 v3, v12 offset:32
    s_mov_b32 m0, 12288
    s_and_b32 s44, s45, s56
    s_add_u32 s44, s44, s41
    s_addk_i32 s45, 0x1000
    buffer_load_dwordx4 v8, s[48:51], s44 offen offset:0 nt lds
    buffer_load_dwordx4 v9, s[48:51], s44 offen offset:1024 nt lds
    buffer_load_dwordx4 v10, s[48:51], s44 offen offset:2048 nt lds
    buffer_load_dwordx4 v11, s[48:51], s44 offen offset:3072 nt lds
    s_waitcnt vmcnt(24)
    v_mov_b32 v12, 48
    ds_write_b32 v3, v12 offset:32
    s_addk_i32 m0, 0x4000
    s_and_b32 s44, s45, s56
    s_add_u32 s44, s44, s41
    s_addk_i32 s45, 0x1000
    buffer_load_dwordx4 v8, s[48:51], s44 offen offset:0 nt lds
    buffer_load_dwordx4 v9, s[48:51], s44 offen offset:1024 nt lds
    buffer_load_dwordx4 v10, s[48:51], s44 offen offset:2048 nt lds
    buffer_load_dwordx4 v11, s[48:51], s44 offen offset:3072 nt lds
    s_waitcnt vmcnt(24)
    v_mov_b32 v12, 52
    ds_write_b32 v3, v12 offset:32
    s_addk_i32 m0, 0x4000
    s_and_b32 s44, s45, s56
    s_add_u32 s44, s44, s41
    s_addk_i32 s45, 0x1000
    buffer_load_dwordx4 v8, s[48:51], s44 offen offset:0 nt lds
    buffer_load_dwordx4 v9, s[48:51], s44 offen offset:1024 nt lds
    buffer_load_dwordx4 v10, s[48:51], s44 offen offset:2048 nt lds
    buffer_load_dwordx4 v11, s[48:51], s44 offen offset:3072 nt lds
    s_waitcnt vmcnt(24)
    v_mov_b32 v12, 56
    ds_write_b32 v3, v12 offset:32
    s_addk_i32 m0, 0x4000
    s_and_b32 s44, s45, s56
    s_add_u32 s44, s44, s41
    s_addk_i32 s45, 0x1000
    buffer_load_dwordx4 v8, s[48:51], s44 offen offset:0 nt lds
    buffer_load_dwordx4 v9, s[48:51], s44 offen offset:1024 nt lds
    buffer_load_dwordx4 v10, s[48:51], s44 offen offset:2048 nt lds
    buffer_load_dwordx4 v11, s[48:51], s44 offen offset:3072 nt lds
    s_waitcnt vmcnt(24)
    v_mov_b32 v12, 60
    ds_write_b32 v3, v12 offset:32
    s_mov_b32 m0, 65536
    s_and_b32 s44, s45, s56
    s_add_u32 s44, s44, s41
    s_addk_i32 s45, 0x1000
    buffer_load_dwordx4 v7, s[52:55], s44 offen offset:0 nt lds
    buffer_load_dwordx4 v7, s[52:55], s44 offen offset:1024 nt lds
    buffer_load_dwordx4 v7, s[52:55], s44 offen offset:2048 nt lds
    buffer_load_dwordx4 v7, s[52:55], s44 offen offset:3072 nt lds
    s_waitcnt vmcnt(24)
    v_mov_b32 v12, 64
    ds_write_b32 v3, v12 offset:32
    s_addk_i32 m0, 0x4000
    s_and_b32 s44, s45, s56
    s_add_u32 s44, s44, s41
    s_addk_i32 s45, 0x1000
    buffer_load_dwordx4 v7, s[52:55], s44 offen offset:0 nt lds
    buffer_load_dwordx4 v7, s[52:55], s44 offen offset:1024 nt lds
    buffer_load_dwordx4 v7, s[52:55], s44 offen offset:2048 nt lds
    buffer_load_dwordx4 v7, s[52:55], s44 offen offset:3072 nt lds
    s_waitcnt vmcnt(24)
    v_mov_b32 v12, 68
    ds_write_b32 v3, v12 offset:32
    s_addk_i32 m0, 0x4000
    s_and_b32 s44, s45, s56
    s_add_u32 s44, s44, s41
    s_addk_i32 s45, 0x1000
    buffer_load_dwordx4 v7, s[52:55], s44 offen offset:0 nt lds
    buffer_load_dwordx4 v7, s[52:55], s44 offen offset:1024 nt lds
    buffer_load_dwordx4 v7, s[52:55], s44 offen offset:2048 nt lds
    buffer_load_dwordx4 v7, s[52:55], s44 offen offset:3072 nt lds
    s_waitcnt vmcnt(24)
    v_mov_b32 v12, 72
    ds_write_b32 v3, v12 offset:32
    s_addk_i32 m0, 0x4000
    s_and_b32 s44, s45, s56
    s_add_u32 s44, s44, s41
    s_addk_i32 s45, 0x1000
    buffer_load_dwordx4 v7, s[52:55], s44 offen offset:0 nt lds
    buffer_load_dwordx4 v7, s[52:55], s44 offen offset:1024 nt lds
    buffer_load_dwordx4 v7, s[52:55], s44 offen offset:2048 nt lds
    buffer_load_dwordx4 v7, s[52:55], s44 offen offset:3072 nt lds
    s_waitcnt vmcnt(24)
    v_mov_b32 v12, 76
    ds_write_b32 v3, v12 offset:32
    s_mov_b32 m0, 69632
    s_and_b32 s44, s45, s56
    s_add_u32 s44, s44, s41
    s_addk_i32 s45, 0x1000
    buffer_load_dwordx4 v7, s[52:55], s44 offen offset:0 nt lds
    buffer_load_dwordx4 v7, s[52:55], s44 offen offset:1024 nt lds
    buffer_load_dwordx4 v7, s[52:55], s44 offen offset:2048 nt lds
    buffer_load_dwordx4 v7, s[52:55], s44 offen offset:3072 nt lds
    s_waitcnt vmcnt(24)
    v_mov_b32 v12, 80
    ds_write_b32 v3, v12 offset:32
    s_addk_i32 m0, 0x4000
    s_and_b32 s44, s45, s56
    s_add_u32 s44, s44, s41
    s_addk_i32 s45, 0x1000
    buffer_load_dwordx4 v7, s[52:55], s44 offen offset:0 nt lds
    buffer_load_dwordx4 v7, s[52:55], s44 offen offset:1024 nt lds
    buffer_load_dwordx4 v7, s[52:55], s44 offen offset:2048 nt lds
    buffer_load_dwordx4 v7, s[52:55], s44 offen offset:3072 nt lds
    s_waitcnt vmcnt(24)
    v_mov_b32 v12, 84
    ds_write_b32 v3, v12 offset:32
    s_addk_i32 m0, 0x4000
    s_and_b32 s44, s45, s56
    s_add_u32 s44, s44, s41
    s_addk_i32 s45, 0x1000
    buffer_load_dwordx4 v7, s[52:55], s44 offen offset:0 nt lds
    buffer_load_dwordx4 v7, s[52:55], s44 offen offset:1024 nt lds
    buffer_load_dwordx4 v7, s[52:55], s44 offen offset:2048 nt lds
    buffer_load_dwordx4 v7, s[52:55], s44 offen offset:3072 nt lds
    s_waitcnt vmcnt(24)
    v_mov_b32 v12, 88
    ds_write_b32 v3, v12 offset:32
    s_addk_i32 m0, 0x4000
    s_and_b32 s44, s45, s56
    s_add_u32 s44, s44, s41
    s_addk_i32 s45, 0x1000
    buffer_load_dwordx4 v7, s[52:55], s44 offen offset:0 nt lds
    buffer_load_dwordx4 v7, s[52:55], s44 offen offset:1024 nt lds
    buffer_load_dwordx4 v7, s[52:55], s44 offen offset:2048 nt lds
    buffer_load_dwordx4 v7, s[52:55], s44 offen offset:3072 nt lds
    s_waitcnt vmcnt(24)
    v_mov_b32 v12, 92
    ds_write_b32 v3, v12 offset:32
    s_mov_b32 m0, 73728
    s_and_b32 s44, s45, s56
    s_add_u32 s44, s44, s41
    s_addk_i32 s45, 0x1000
    buffer_load_dwordx4 v7, s[52:55], s44 offen offset:0 nt lds
    buffer_load_dwordx4 v7, s[52:55], s44 offen offset:1024 nt lds
    buffer_load_dwordx4 v7, s[52:55], s44 offen offset:2048 nt lds
    buffer_load_dwordx4 v7, s[52:55], s44 offen offset:3072 nt lds
    s_waitcnt vmcnt(24)
    v_mov_b32 v12, 96
    ds_write_b32 v3, v12 offset:32
    s_addk_i32 m0, 0x4000
    s_and_b32 s44, s45, s56
    s_add_u32 s44, s44, s41
    s_addk_i32 s45, 0x1000
    buffer_load_dwordx4 v7, s[52:55], s44 offen offset:0 nt lds
    buffer_load_dwordx4 v7, s[52:55], s44 offen offset:1024 nt lds
    buffer_load_dwordx4 v7, s[52:55], s44 offen offset:2048 nt lds
    buffer_load_dwordx4 v7, s[52:55], s44 offen offset:3072 nt lds
    s_waitcnt vmcnt(24)
    v_mov_b32 v12, 100
    ds_write_b32 v3, v12 offset:32
    s_addk_i32 m0, 0x4000
    s_and_b32 s44, s45, s56
    s_add_u32 s44, s44, s41
    s_addk_i32 s45, 0x1000
    buffer_load_dwordx4 v7, s[52:55], s44 offen offset:0 nt lds
    buffer_load_dwordx4 v7, s[52:55], s44 offen offset:1024 nt lds
    buffer_load_dwordx4 v7, s[52:55], s44 offen offset:2048 nt lds
    buffer_load_dwordx4 v7, s[52:55], s44 offen offset:3072 nt lds
    s_waitcnt vmcnt(24)
    v_mov_b32 v12, 104
    ds_write_b32 v3, v12 offset:32
    s_addk_i32 m0, 0x4000
    s_and_b32 s44, s45, s56
    s_add_u32 s44, s44, s41
    s_addk_i32 s45, 0x1000
    buffer_load_dwordx4 v7, s[52:55], s44 offen offset:0 nt lds
    buffer_load_dwordx4 v7, s[52:55], s44 offen offset:1024 nt lds
    buffer_load_dwordx4 v7, s[52:55], s44 offen offset:2048 nt lds
    buffer_load_dwordx4 v7, s[52:55], s44 offen offset:3072 nt lds
    s_waitcnt vmcnt(24)
    v_mov_b32 v12, 108
    ds_write_b32 v3, v12 offset:32
    s_mov_b32 m0, 77824
    s_and_b32 s44, s45, s56
    s_add_u32 s44, s44, s41
    s_addk_i32 s45, 0x1000
    buffer_load_dwordx4 v7, s[52:55], s44 offen offset:0 nt lds
    buffer_load_dwordx4 v7, s[52:55], s44 offen offset:1024 nt lds
    buffer_load_dwordx4 v7, s[52:55], s44 offen offset:2048 nt lds
    buffer_load_dwordx4 v7, s[52:55], s44 offen offset:3072 nt lds
    s_waitcnt vmcnt(24)
    v_mov_b32 v12, 112
    ds_write_b32 v3, v12 offset:32
    s_addk_i32 m0, 0x4000
    s_and_b32 s44, s45, s56
    s_add_u32 s44, s44, s41
    s_addk_i32 s45, 0x1000
    buffer_load_dwordx4 v7, s[52:55], s44 offen offset:0 nt lds
    buffer_load_dwordx4 v7, s[52:55], s44 offen offset:1024 nt lds
    buffer_load_dwordx4 v7, s[52:55], s44 offen offset:2048 nt lds
    buffer_load_dwordx4 v7, s[52:55], s44 offen offset:3072 nt lds
    s_waitcnt vmcnt(24)
    v_mov_b32 v12, 116
    ds_write_b32 v3, v12 offset:32
    s_addk_i32 m0, 0x4000
    s_and_b32 s44, s45, s56
    s_add_u32 s44, s44, s41
    s_addk_i32 s45, 0x1000
    buffer_load_dwordx4 v7, s[52:55], s44 offen offset:0 nt lds
    buffer_load_dwordx4 v7, s[52:55], s44 offen offset:1024 nt lds
    buffer_load_dwordx4 v7, s[52:55], s44 offen offset:2048 nt lds
    buffer_load_dwordx4 v7, s[52:55], s44 offen offset:3072 nt lds
    s_waitcnt vmcnt(24)
    v_mov_b32 v12, 120
    ds_write_b32 v3, v12 offset:32
    s_addk_i32 m0, 0x4000
    s_and_b32 s44, s45, s56
    s_add_u32 s44, s44, s41
    s_addk_i32 s45, 0x1000
    buffer_load_dwordx4 v7, s[52:55], s44 offen offset:0 nt lds
    buffer_load_dwordx4 v7, s[52:55], s44 offen offset:1024 nt lds
    buffer_load_dwordx4 v7, s[52:55], s44 offen offset:2048 nt lds
    buffer_load_dwordx4 v7, s[52:55], s44 offen offset:3072 nt lds
    s_waitcnt vmcnt(24)
    v_mov_b32 v12, 124
    ds_write_b32 v3, v12 offset:32
    s_waitcnt vmcnt(20)
    v_mov_b32 v12, 128
    ds_write_b32 v3, v12 offset:32
    s_waitcnt vmcnt(16)
    v_mov_b32 v12, 132
    ds_write_b32 v3, v12 offset:32
    s_waitcnt vmcnt(12)
    v_mov_b32 v12, 136
    ds_write_b32 v3, v12 offset:32
    s_waitcnt vmcnt(8)
    v_mov_b32 v12, 140
    ds_write_b32 v3, v12 offset:32
    s_waitcnt vmcnt(4)
    v_mov_b32 v12, 144
    ds_write_b32 v3, v12 offset:32
    s_waitcnt vmcnt(0)
    v_mov_b32 v12, 148
    ds_write_b32 v3, v12 offset:32
    s_endpgm
    .p2align 12
L_roleQ:
    s_setprio 3
    s_lshr_b32 s42, s29, 2
    v_lshlrev_b32 v4, 4, v0
    v_add_u32 v54, 131072, v4
    v_lshlrev_b32 v5, 2, v0
    v_add_u32 v5, 150528, v5
    v_and_b32 v52, 1, v1
    v_lshlrev_b32 v52, 4, v52
    v_mov_b32 v53, 0xffff
    v_lshlrev_b32 v52, v52, v53
    v_lshrrev_b32 v53, 1, v1
    v_cmp_eq_u32 vcc, 0, v53
    s_nop 1
    v_cndmask_b32 v48, 0, v52, vcc
    v_cmp_eq_u32 vcc, 1, v53
    s_nop 1
    v_cndmask_b32 v49, 0, v52, vcc
    v_cmp_eq_u32 vcc, 2, v53
    s_nop 1
    v_cndmask_b32 v50, 0, v52, vcc
    v_cmp_eq_u32 vcc, 3, v53
    s_nop 1
    v_cndmask_b32 v51, 0, v52, vcc
    s_getreg_b32 s61, hwreg(HW_REG_XCC_ID, 0, 4)
    s_waitcnt lgkmcnt(0)
    s_load_dword s60, s[26:27], 901120
    s_mov_b64 s[44:45], s[26:27]
    s_mov_b32 s46, 901376
    s_mov_b32 s47, 0x20000
    s_mov_b32 s78, 400000
L_sp_2:
    ds_read_b32 v6, v3 offset:32
    s_waitcnt lgkmcnt(0)
    v_readfirstlane_b32 s79, v6
    s_cmp_ge_u32 s79, 2
    s_cbranch_scc1 L_spd_3
    s_sub_u32 s78, s78, 1
    s_cbranch_scc0 L_sp_2
L_spd_3:
    ds_read_b128 v[8:11], v54 offset:18432
    ds_read_b32 v12, v5
    s_waitcnt lgkmcnt(0)
    v_lshlrev_b32 v14, 16, v8
    v_and_b32 v15, 0xffff0000, v8
    v_lshlrev_b32 v16, 16, v9
    v_and_b32 v17, 0xffff0000, v9
    v_lshlrev_b32 v18, 16, v10
    v_and_b32 v19, 0xffff0000, v10
    v_lshlrev_b32 v20, 16, v11
    v_and_b32 v21, 0xffff0000, v11
    v_lshlrev_b32 v22, 16, v12
    v_and_b32 v23, 0xffff0000, v12
    v_add_f32 v24, v14, v15
    v_add_f32 v24, v24, v16
    v_add_f32 v24, v24, v17
    v_add_f32 v24, v24, v18
    v_add_f32 v24, v24, v19
    v_add_f32 v24, v24, v20
    v_add_f32 v24, v24, v21
    v_add_f32 v24, v24, v22
    v_add_f32 v24, v24, v23
    s_nop 1
    v_add_f32_dpp v24, v24, v24 quad_perm:[1,0,3,2] row_mask:0xf bank_mask:0xf
    s_nop 1
    v_add_f32_dpp v24, v24, v24 quad_perm:[2,3,0,1] row_mask:0xf bank_mask:0xf
    s_nop 1
    v_add_f32_dpp v24, v24, v24 row_half_mirror row_mask:0xf bank_mask:0xf
    s_nop 1
    v_add_f32_dpp v24, v24, v24 row_mirror row_mask:0xf bank_mask:0xf
    v_mov_b32 v25, v24
    s_nop 1
    v_permlane16_swap_b32 v24, v25
    v_add_f32 v24, v24, v25
    v_mov_b32 v25, v24
    s_nop 1
    v_permlane32_swap_b32 v24, v25
    v_add_f32 v24, v24, v25
    v_mul_f32 v24, 0x3ae38e39, v24
    v_sub_f32 v26, v14, v24
    v_mul_f32 v25, v26, v26
    v_sub_f32 v26, v15, v24
    v_fmac_f32 v25, v26, v26
    v_sub_f32 v26, v16, v24
    v_fmac_f32 v25, v26, v26
    v_sub_f32 v26, v17, v24
    v_fmac_f32 v25, v26, v26
    v_sub_f32 v26, v18, v24
    v_fmac_f32 v25, v26, v26
    v_sub_f32 v26, v19, v24
    v_fmac_f32 v25, v26, v26
    v_sub_f32 v26, v20, v24
    v_fmac_f32 v25, v26, v26
    v_sub_f32 v26, v21, v24
    v_fmac_f32 v25, v26, v26
    s_mov_b32 exec_hi, 0
    v_sub_f32 v26, v22, v24
    v_fmac_f32 v25, v26, v26
    v_sub_f32 v26, v23, v24
    v_fmac_f32 v25, v26, v26
    s_mov_b32 exec_hi, -1
    s_nop 1
    v_add_f32_dpp v25, v25, v25 quad_perm:[1,0,3,2] row_mask:0xf bank_mask:0xf
    s_nop 1
    v_add_f32_dpp v25, v25, v25 quad_perm:[2,3,0,1] row_mask:0xf bank_mask:0xf
    s_nop 1
    v_add_f32_dpp v25, v25, v25 row_half_mirror row_mask:0xf bank_mask:0xf
    s_nop 1
    v_add_f32_dpp v25, v25, v25 row_mirror row_mask:0xf bank_mask:0xf
    v_mov_b32 v26, v25
    s_nop 1
    v_permlane16_swap_b32 v25, v26
    v_add_f32 v25, v25, v26
    v_mov_b32 v26, v25
    s_nop 1
    v_permlane32_swap_b32 v25, v26
    v_add_f32 v25, v25, v26
    v_mul_f32 v25, 0x3ae38e39, v25
    v_cvt_pk_bf16_f32 v25, v24, v25
    v_lshlrev_b32 v24, 16, v25
    v_and_b32 v25, 0xffff0000, v25
    v_add_f32 v25, 0x3727c5ac, v25
    v_cvt_pk_bf16_f32 v25, v25, v25
    v_and_b32 v25, 0xffff0000, v25
    v_sqrt_f32 v25, v25
    s_nop 0
    v_cvt_pk_bf16_f32 v25, v25, v25
    v_and_b32 v25, 0xffff0000, v25
    v_rcp_f32 v26, v25
    v_sub_f32 v14, v14, v24
    v_sub_f32 v15, v15, v24
    v_sub_f32 v16, v16, v24
    v_sub_f32 v17, v17, v24
    v_sub_f32 v18, v18, v24
    v_sub_f32 v19, v19, v24
    v_sub_f32 v20, v20, v24
    v_sub_f32 v21, v21, v24
    v_sub_f32 v22, v22, v24
    v_sub_f32 v23, v23, v24
    v_cvt_pk_bf16_f32 v15, v14, v15
    v_lshlrev_b32 v14, 16, v15
    v_and_b32 v15, 0xffff0000, v15
    v_cvt_pk_bf16_f32 v17, v16, v17
    v_lshlrev_b32 v16, 16, v17
    v_and_b32 v17, 0xffff0000, v17
    v_cvt_pk_bf16_f32 v19, v18, v19
    v_lshlrev_b32 v18, 16, v19
    v_and_b32 v19, 0xffff0000, v19
    v_cvt_pk_bf16_f32 v21, v20, v21
    v_lshlrev_b32 v20, 16, v21
    v_and_b32 v21, 0xffff0000, v21
    v_cvt_pk_bf16_f32 v23, v22, v23
    v_lshlrev_b32 v22, 16, v23
    v_and_b32 v23, 0xffff0000, v23
    v_mul_f32 v27, v14, v26
    v_fma_f32 v14, -v27, v25, v14
    v_fma_f32 v27, v14, v26, v27
    v_cvt_pk_bf16_f32 v28, v27, v27
    v_mul_f32 v27, v15, v26
    v_fma_f32 v15, -v27, v25, v15
    v_fma_f32 v27, v15, v26, v27
    v_cvt_pk_bf16_f32 v29, v27, v27
    v_mul_f32 v27, v16, v26
    v_fma_f32 v16, -v27, v25, v16
    v_fma_f32 v27, v16, v26, v27
    v_cvt_pk_bf16_f32 v30, v27, v27
    v_mul_f32 v27, v17, v26
    v_fma_f32 v17, -v27, v25, v17
    v_fma_f32 v27, v17, v26, v27
    v_cvt_pk_bf16_f32 v31, v27, v27
    v_mul_f32 v27, v18, v26
    v_fma_f32 v18, -v27, v25, v18
    v_fma_f32 v27, v18, v26, v27
    v_cvt_pk_bf16_f32 v32, v27, v27
    v_mul_f32 v27, v19, v26
    v_fma_f32 v19, -v27, v25, v19
    v_fma_f32 v27, v19, v26, v27
    v_cvt_pk_bf16_f32 v33, v27, v27
    v_mul_f32 v27, v20, v26
    v_fma_f32 v20, -v27, v25, v20
    v_fma_f32 v27, v20, v26, v27
    v_cvt_pk_bf16_f32 v34, v27, v27
    v_mul_f32 v27, v21, v26
    v_fma_f32 v21, -v27, v25, v21
    v_fma_f32 v27, v21, v26, v27
    v_cvt_pk_bf16_f32 v35, v27, v27
    v_mul_f32 v27, v22, v26
    v_fma_f32 v22, -v27, v25, v22
    v_fma_f32 v27, v22, v26, v27
    v_cvt_pk_bf16_f32 v36, v27, v27
    v_mul_f32 v27, v23, v26
    v_fma_f32 v23, -v27, v25, v23
    v_fma_f32 v27, v23, v26, v27
    v_cvt_pk_bf16_f32 v37, v27, v27
    v_lshlrev_b32 v4, 5, v0
    v_add_u32 v4, 150784, v4
    ds_write_b128 v4, v[28:31]
    ds_write_b128 v4, v[32:35] offset:16
    v_lshlrev_b32 v7, 3, v0
    v_add_u32 v7, 152832, v7
    s_mov_b32 exec_hi, 0
    ds_write_b64 v7, v[36:37]
    s_mov_b32 exec_hi, -1
    v_mov_b32 v5, 1
    ds_write_b32 v3, v5 offset:0
    s_lshr_b32 s43, s29, 1
    s_mul_i32 s43, s43, 288
    s_add_u32 s43, s43, 150784
    v_lshrrev_b32 v6, 4, v0
    v_lshl_add_u32 v6, v6, 2, s43
    ds_read2_b32 v[8:9], v6 offset0:0 offset1:4
    ds_read2_b32 v[10:11], v6 offset0:8 offset1:12
    ds_read2_b32 v[12:13], v6 offset0:16 offset1:20
    ds_read2_b32 v[14:15], v6 offset0:24 offset1:28
    ds_read2_b32 v[16:17], v6 offset0:32 offset1:36
    ds_read2_b32 v[18:19], v6 offset0:40 offset1:44
    ds_read2_b32 v[20:21], v6 offset0:48 offset1:52
    ds_read2_b32 v[22:23], v6 offset0:56 offset1:60
    ds_read2_b32 v[24:25], v6 offset0:64 offset1:68
    s_mov_b32 s78, 400000
L_sp_4:
    ds_read_b32 v5, v3 offset:32
    s_waitcnt lgkmcnt(0)
    v_readfirstlane_b32 s79, v5
    s_cmp_ge_u32 s79, 11
    s_cbranch_scc1 L_spd_5
    s_sub_u32 s78, s78, 1
    s_cbranch_scc0 L_sp_4
L_spd_5:
    ds_read_b128 v[56:59], v54 offset:0
    ds_read_b128 v[60:63], v54 offset:1024
    ds_read_b128 v[64:67], v54 offset:2048
    ds_read_b128 v[68:71], v54 offset:3072
    ds_read_b128 v[72:75], v54 offset:4096
    ds_read_b128 v[76:79], v54 offset:5120
    ds_read_b128 v[80:83], v54 offset:6144
    ds_read_b128 v[84:87], v54 offset:7168
    ds_read_b128 v[88:91], v54 offset:8192
    v_and_b32 v28, v8, v48
    v_and_b32 v29, v8, v49
    v_and_b32 v30, v8, v50
    v_and_b32 v31, v8, v51
    v_and_b32 v32, v9, v48
    v_and_b32 v33, v9, v49
    v_and_b32 v34, v9, v50
    v_and_b32 v35, v9, v51
    s_waitcnt lgkmcnt(8)
    v_mfma_f32_16x16x32_bf16 v[36:39], v[28:31], v[56:59], 0
    v_and_b32 v28, v10, v48
    v_and_b32 v29, v10, v49
    v_and_b32 v30, v10, v50
    v_and_b32 v31, v10, v51
    s_waitcnt lgkmcnt(7)
    v_mfma_f32_16x16x32_bf16 v[36:39], v[32:35], v[60:63], v[36:39]
    v_and_b32 v32, v11, v48
    v_and_b32 v33, v11, v49
    v_and_b32 v34, v11, v50
    v_and_b32 v35, v11, v51
    s_waitcnt lgkmcnt(6)
    v_mfma_f32_16x16x32_bf16 v[36:39], v[28:31], v[64:67], v[36:39]
    v_and_b32 v28, v12, v48
    v_and_b32 v29, v12, v49
    v_and_b32 v30, v12, v50
    v_and_b32 v31, v12, v51
    s_waitcnt lgkmcnt(5)
    v_mfma_f32_16x16x32_bf16 v[36:39], v[32:35], v[68:71], v[36:39]
    v_and_b32 v32, v13, v48
    v_and_b32 v33, v13, v49
    v_and_b32 v34, v13, v50
    v_and_b32 v35, v13, v51
    s_waitcnt lgkmcnt(4)
    v_mfma_f32_16x16x32_bf16 v[36:39], v[28:31], v[72:75], v[36:39]
    v_and_b32 v28, v14, v48
    v_and_b32 v29, v14, v49
    v_and_b32 v30, v14, v50
    v_and_b32 v31, v14, v51
    s_waitcnt lgkmcnt(3)
    v_mfma_f32_16x16x32_bf16 v[36:39], v[32:35], v[76:79], v[36:39]
    v_and_b32 v32, v15, v48
    v_and_b32 v33, v15, v49
    v_and_b32 v34, v15, v50
    v_and_b32 v35, v15, v51
    s_waitcnt lgkmcnt(2)
    v_mfma_f32_16x16x32_bf16 v[36:39], v[28:31], v[80:83], v[36:39]
    v_and_b32 v28, v16, v48
    v_and_b32 v29, v16, v49
    v_and_b32 v30, v16, v50
    v_and_b32 v31, v16, v51
    s_waitcnt lgkmcnt(1)
    v_mfma_f32_16x16x32_bf16 v[36:39], v[32:35], v[84:87], v[36:39]
    s_nop 0
    s_waitcnt lgkmcnt(0)
    v_mfma_f32_16x16x32_bf16 v[36:39], v[28:31], v[88:91], v[36:39]
    s_mov_b32 s78, 400000
L_sp_6:
    ds_read_b32 v5, v3 offset:32
    s_waitcnt lgkmcnt(0)
    v_readfirstlane_b32 s79, v5
    s_cmp_ge_u32 s79, 20
    s_cbranch_scc1 L_spd_7
    s_sub_u32 s78, s78, 1
    s_cbranch_scc0 L_sp_6
L_spd_7:
    ds_read_b128 v[92:95], v54 offset:9216
    ds_read_b128 v[96:99], v54 offset:10240
    ds_read_b128 v[100:103], v54 offset:11264
    ds_read_b128 v[104:107], v54 offset:12288
    ds_read_b128 v[108:111], v54 offset:13312
    ds_read_b128 v[112:115], v54 offset:14336
    ds_read_b128 v[116:119], v54 offset:15360
    ds_read_b128 v[120:123], v54 offset:16384
    ds_read_b128 v[124:127], v54 offset:17408
    v_and_b32 v32, v17, v48
    v_and_b32 v33, v17, v49
    v_and_b32 v34, v17, v50
    v_and_b32 v35, v17, v51
    v_and_b32 v28, v18, v48
    v_and_b32 v29, v18, v49
    v_and_b32 v30, v18, v50
    v_and_b32 v31, v18, v51
    s_waitcnt lgkmcnt(8)
    v_mfma_f32_16x16x32_bf16 v[36:39], v[32:35], v[92:95], v[36:39]
    v_and_b32 v32, v19, v48
    v_and_b32 v33, v19, v49
    v_and_b32 v34, v19, v50
    v_and_b32 v35, v19, v51
    s_waitcnt lgkmcnt(7)
    v_mfma_f32_16x16x32_bf16 v[36:39], v[28:31], v[96:99], v[36:39]
    v_and_b32 v28, v20, v48
    v_and_b32 v29, v20, v49
    v_and_b32 v30, v20, v50
    v_and_b32 v31, v20, v51
    s_waitcnt lgkmcnt(6)
    v_mfma_f32_16x16x32_bf16 v[36:39], v[32:35], v[100:103], v[36:39]
    v_and_b32 v32, v21, v48
    v_and_b32 v33, v21, v49
    v_and_b32 v34, v21, v50
    v_and_b32 v35, v21, v51
    s_waitcnt lgkmcnt(5)
    v_mfma_f32_16x16x32_bf16 v[36:39], v[28:31], v[104:107], v[36:39]
    v_and_b32 v28, v22, v48
    v_and_b32 v29, v22, v49
    v_and_b32 v30, v22, v50
    v_and_b32 v31, v22, v51
    s_waitcnt lgkmcnt(4)
    v_mfma_f32_16x16x32_bf16 v[36:39], v[32:35], v[108:111], v[36:39]
    v_and_b32 v32, v23, v48
    v_and_b32 v33, v23, v49
    v_and_b32 v34, v23, v50
    v_and_b32 v35, v23, v51
    s_waitcnt lgkmcnt(3)
    v_mfma_f32_16x16x32_bf16 v[36:39], v[28:31], v[112:115], v[36:39]
    v_and_b32 v28, v24, v48
    v_and_b32 v29, v24, v49
    v_and_b32 v30, v24, v50
    v_and_b32 v31, v24, v51
    s_waitcnt lgkmcnt(2)
    v_mfma_f32_16x16x32_bf16 v[36:39], v[32:35], v[116:119], v[36:39]
    v_and_b32 v32, v25, v48
    v_and_b32 v33, v25, v49
    v_and_b32 v34, v25, v50
    v_and_b32 v35, v25, v51
    s_waitcnt lgkmcnt(1)
    v_mfma_f32_16x16x32_bf16 v[36:39], v[28:31], v[120:123], v[36:39]
    s_nop 0
    s_waitcnt lgkmcnt(0)
    v_mfma_f32_16x16x32_bf16 v[36:39], v[32:35], v[124:127], v[36:39]
    s_add_u32 s60, s60, 1
    s_add_u32 s65, s79, 20
    s_mov_b32 s56, s60
    s_add_u32 s57, s60, 53
    s_add_u32 s58, s60, 106
    s_add_u32 s59, s60, 159
    v_mov_b32 v12, 0xff
    v_and_b32 v6, 15, v0
    v_lshlrev_b32 v6, 5, v6
    v_and_b32 v5, 16, v0
    v_add_u32 v6, v6, v5
    s_nop 0
    v_add_u32 v8, 0x80, v36
    v_add_u32 v9, 0x80, v37
    v_add_u32 v10, 0x80, v38
    v_add_u32 v11, 0x80, v39
    v_bfi_b32 v8, v12, s56, v8
    v_bfi_b32 v9, v12, s57, v9
    v_bfi_b32 v10, v12, s58, v10
    v_bfi_b32 v11, v12, s59, v11
    s_mov_b32 exec_hi, 0
    buffer_store_dwordx4 v[8:11], v6, s[44:47], s74 offen offset:0
    s_mov_b64 exec, -1
    v_lshrrev_b32 v5, 5, v0
    v_mul_u32_u24 v5, 2944, v5
    v_and_b32 v7, 31, v0
    v_lshl_add_u32 v55, v7, 4, v5
    v_mul_u32_u24 v7, 2944, v7
    s_mul_i32 s48, s28, 47104
    s_add_u32 s49, s48, 5888
    s_add_u32 s50, s48, 11776
    s_add_u32 s51, s48, 17664
    s_add_u32 s52, s48, 23552
    s_add_u32 s53, s48, 29440
    s_add_u32 s54, s48, 35328
    s_add_u32 s55, s48, 41216
    v_lshlrev_b32 v4, 4, v0
    s_mov_b32 s62, 1
    s_mov_b32 s63, 0
    s_mov_b32 s77, 40000
    s_mov_b32 s64, 12
    s_min_u32 s65, s65, 148
    s_mov_b32 s78, 400000
L_sp_8:
    ds_read_b32 v5, v3 offset:32
    s_waitcnt lgkmcnt(0)
    v_readfirstlane_b32 s79, v5
    s_cmp_ge_u32 s79, s65
    s_cbranch_scc1 L_spd_9
    s_sleep 1
    s_sub_u32 s78, s78, 1
    s_cbranch_scc0 L_sp_8
L_spd_9:
L_qpoll:
    buffer_load_dwordx2 v[12:13], v7, s[44:47], s75 offen offset:512 sc1
    s_cmp_lg_u32 s63, 0
    s_cbranch_scc1 L_qhave
    buffer_load_dwordx4 v[16:19], v55, s[44:47], s48 offen sc1
    buffer_load_dwordx4 v[20:23], v55, s[44:47], s49 offen sc1
    buffer_load_dwordx4 v[24:27], v55, s[44:47], s50 offen sc1
    buffer_load_dwordx4 v[28:31], v55, s[44:47], s51 offen sc1
    buffer_load_dwordx4 v[32:35], v55, s[44:47], s52 offen sc1
    buffer_load_dwordx4 v[36:39], v55, s[44:47], s53 offen sc1
    buffer_load_dwordx4 v[40:43], v55, s[44:47], s54 offen sc1
    buffer_load_dwordx4 v[44:47], v55, s[44:47], s55 offen sc1
    s_waitcnt vmcnt(0)
    v_bitop3_b32 v5, v16, v20, s56 bitop3:0x7e
    v_bitop3_b32 v5, v5, v17, s57 bitop3:0xf6
    v_bitop3_b32 v5, v5, v18, s58 bitop3:0xf6
    v_bitop3_b32 v5, v5, v19, s59 bitop3:0xf6
    v_bitop3_b32 v5, v5, v21, s57 bitop3:0xf6
    v_bitop3_b32 v5, v5, v22, s58 bitop3:0xf6
    v_bitop3_b32 v5, v5, v23, s59 bitop3:0xf6
    v_bitop3_b32 v5, v5, v24, s56 bitop3:0xf6
    v_bitop3_b32 v5, v5, v25, s57 bitop3:0xf6
    v_bitop3_b32 v5, v5, v26, s58 bitop3:0xf6
    v_bitop3_b32 v5, v5, v27, s59 bitop3:0xf6
    v_bitop3_b32 v5, v5, v28, s56 bitop3:0xf6
    v_bitop3_b32 v5, v5, v29, s57 bitop3:0xf6
    v_bitop3_b32 v5, v5, v30, s58 bitop3:0xf6
    v_bitop3_b32 v5, v5, v31, s59 bitop3:0xf6
    v_bitop3_b32 v5, v5, v32, s56 bitop3:0xf6
    v_bitop3_b32 v5, v5, v33, s57 bitop3:0xf6
    v_bitop3_b32 v5, v5, v34, s58 bitop3:0xf6
    v_bitop3_b32 v5, v5, v35, s59 bitop3:0xf6
    v_bitop3_b32 v5, v5, v36, s56 bitop3:0xf6
    v_bitop3_b32 v5, v5, v37, s57 bitop3:0xf6
    v_bitop3_b32 v5, v5, v38, s58 bitop3:0xf6
    v_bitop3_b32 v5, v5, v39, s59 bitop3:0xf6
    v_bitop3_b32 v5, v5, v40, s56 bitop3:0xf6
    v_bitop3_b32 v5, v5, v41, s57 bitop3:0xf6
    v_bitop3_b32 v5, v5, v42, s58 bitop3:0xf6
    v_bitop3_b32 v5, v5, v43, s59 bitop3:0xf6
    v_bitop3_b32 v5, v5, v44, s56 bitop3:0xf6
    v_bitop3_b32 v5, v5, v45, s57 bitop3:0xf6
    v_bitop3_b32 v5, v5, v46, s58 bitop3:0xf6
    v_bitop3_b32 v5, v5, v47, s59 bitop3:0xf6
    v_and_b32 v5, 0xff, v5
    v_cmp_ne_u32 vcc, 0, v5
    s_cmp_eq_u32 s77, 0
    s_cbranch_scc1 L_qtake
    s_cbranch_vccnz L_qhave
L_qtake:
    s_movk_i32 s43, 0xff00
    v_and_b32 v16, s43, v16
    v_and_b32 v17, s43, v17
    v_and_b32 v18, s43, v18
    v_and_b32 v19, s43, v19
    v_and_b32 v20, s43, v20
    v_and_b32 v21, s43, v21
    v_and_b32 v22, s43, v22
    v_and_b32 v23, s43, v23
    v_and_b32 v24, s43, v24
    v_and_b32 v25, s43, v25
    v_and_b32 v26, s43, v26
    v_and_b32 v27, s43, v27
    v_and_b32 v28, s43, v28
    v_and_b32 v29, s43, v29
    v_and_b32 v30, s43, v30
    v_and_b32 v31, s43, v31
    v_and_b32 v32, s43, v32
    v_and_b32 v33, s43, v33
    v_and_b32 v34, s43, v34
    v_and_b32 v35, s43, v35
    v_and_b32 v36, s43, v36
    v_and_b32 v37, s43, v37
    v_and_b32 v38, s43, v38
    v_and_b32 v39, s43, v39
    v_and_b32 v40, s43, v40
    v_and_b32 v41, s43, v41
    v_and_b32 v42, s43, v42
    v_and_b32 v43, s43, v43
    v_and_b32 v44, s43, v44
    v_and_b32 v45, s43, v45
    v_and_b32 v46, s43, v46
    v_and_b32 v47, s43, v47
    v_pk_add_f32 v[16:17], v[16:17], v[32:33]
    v_pk_add_f32 v[18:19], v[18:19], v[34:35]
    v_pk_add_f32 v[20:21], v[20:21], v[36:37]
    v_pk_add_f32 v[22:23], v[22:23], v[38:39]
    v_pk_add_f32 v[24:25], v[24:25], v[40:41]
    v_pk_add_f32 v[26:27], v[26:27], v[42:43]
    v_pk_add_f32 v[28:29], v[28:29], v[44:45]
    v_pk_add_f32 v[30:31], v[30:31], v[46:47]
    v_pk_add_f32 v[16:17], v[16:17], v[24:25]
    v_pk_add_f32 v[18:19], v[18:19], v[26:27]
    v_pk_add_f32 v[20:21], v[20:21], v[28:29]
    v_pk_add_f32 v[22:23], v[22:23], v[30:31]
    v_pk_add_f32 v[16:17], v[16:17], v[20:21]
    v_pk_add_f32 v[18:19], v[18:19], v[22:23]
    v_cvt_pk_bf16_f32 v14, v16, v17
    v_cvt_pk_bf16_f32 v15, v18, v19
    v_lshlrev_b32 v5, 3, v0
    v_add_u32 v5, 153088, v5
    ds_write_b64 v5, v[14:15]
    v_mov_b32 v52, 1
    ds_write_b32 v3, v52 offset:12
    s_mov_b32 s63, 1
L_qhave:
    s_waitcnt vmcnt(0)
    v_cmp_eq_u32 s[66:67], s60, v13
    v_and_b32 v5, 15, v12
    v_cmp_ne_u32 s[68:69], s61, v5
    v_cmp_lt_u32 s[70:71], 64, v12
    s_and_b64 s[72:73], s[66:67], s[68:69]
    s_cselect_b32 s65, s62, 2
    s_andn2_b64 s[68:69], s[68:69], s[70:71]
    s_andn2_b64 s[66:67], s[66:67], s[68:69]
    s_cmp_eq_u32 s65, 1
    s_cbranch_scc1 L_goglobal
    s_cmp_eq_u64 s[66:67], -1
    s_cselect_b32 s65, s63, 0
    s_cmp_lg_u32 s65, 0
    s_cbranch_scc1 L_qdone
    s_sub_u32 s77, s77, 1
    s_cbranch_scc1 L_qdone
    s_sub_u32 s64, s64, 1
    s_cbranch_scc0 L_qpoll
    s_cmp_eq_u32 s62, 2
    s_cbranch_scc1 L_qpoll
    s_branch L_goglobal
L_qdone:
    v_and_b32 v5, 16, v12
    v_cmp_ne_u32 vcc, 0, v5
    s_bcnt1_i32_b64 s65, vcc
    s_cmp_gt_u32 s65, 10
    s_cselect_b32 s65, 0x2000, 0
    v_mov_b32 v14, s65
    ds_write_b32 v3, v14 offset:52
    s_mov_b32 s78, 400000
L_sp_10:
    ds_read_b32 v5, v3 offset:4
    s_waitcnt lgkmcnt(0)
    v_readfirstlane_b32 s79, v5
    s_cmp_ge_u32 s79, 1
    s_cbranch_scc1 L_spd_11
    s_sleep 1
    s_sub_u32 s78, s78, 1
    s_cbranch_scc0 L_sp_10
L_spd_11:
    v_mov_b32 v5, s62
    ds_write_b32 v3, v5 offset:8
    s_mov_b32 s77, 40000
    v_lshrrev_b32 v24, 4, v0
    s_cmp_ge_u32 s29, 8
    s_cbranch_scc1 L_Gw2
    v_lshrrev_b32 v4, 2, v0
    v_mul_u32_u24 v4, 2944, v4
    v_and_b32 v6, 3, v0
    v_lshl_add_u32 v5, v6, 4, v4
    s_lshr_b32 s42, s30, 2
    s_lshl_b32 s42, s42, 3
    s_add_u32 s42, s42, s48
    s_lshl_b32 s43, s30, 6
    s_add_u32 s43, s43, s48
    s_mov_b32 s50, 0x3fb8aa3b
    v_lshlrev_b32 v6, 5, v6
    v_lshl_add_u32 v6, v24, 3, v6
    v_add_u32 v6, 157792, v6
    s_mov_b32 s78, 400000
L_sp_12:
    ds_read_b32 v7, v3 offset:36
    s_waitcnt lgkmcnt(0)
    v_readfirstlane_b32 s79, v7
    s_cmp_ge_u32 s79, 5
    s_cbranch_scc1 L_spd_13
    s_sub_u32 s78, s78, 1
    s_cbranch_scc0 L_sp_12
L_spd_13:
L_opoll:
    buffer_load_dwordx2 v[8:9], v4, s[44:47], s42 offen offset:528 sc1
    buffer_load_dwordx4 v[12:15], v5, s[44:47], s43 offen offset:640 sc1
    v_mov_b32 v7, 1
    ds_write_b32 v3, v7 offset:28
    s_waitcnt vmcnt(0)
    v_max3_u32 v7, v8, v9, v12
    v_max3_u32 v7, v7, v13, v14
    v_max_u32 v7, v7, v15
    v_cmp_eq_u32 vcc, -1, v7
    s_cbranch_vccz L_ok_14
    s_sub_u32 s77, s77, 1
    s_cbranch_scc0 L_opoll
L_ok_14:
    v_max_f32_dpp v10, v8, v8 row_ror:4 row_mask:0xf bank_mask:0xf
    v_lshlrev_b32 v16, 16, v12
    v_and_b32 v17, 0xffff0000, v12
    v_lshlrev_b32 v18, 16, v13
    v_and_b32 v19, 0xffff0000, v13
    v_lshlrev_b32 v20, 16, v14
    v_and_b32 v21, 0xffff0000, v14
    v_lshlrev_b32 v22, 16, v15
    v_and_b32 v23, 0xffff0000, v15
    v_max_f32_dpp v10, v10, v10 row_ror:8 row_mask:0xf bank_mask:0xf
    v_mov_b32 v11, v10
    s_nop 1
    v_permlane16_swap_b32 v10, v11
    v_max_f32 v10, v10, v11
    v_mov_b32 v11, v10
    s_nop 1
    v_permlane32_swap_b32 v10, v11
    v_max_f32 v10, v10, v11
    v_sub_f32 v8, v8, v10
    v_mul_f32 v8, s50, v8
    v_exp_f32 v8, v8
    s_nop 0
    v_mul_f32 v9, v8, v9
    v_mul_f32 v16, v8, v16
    v_mul_f32 v17, v8, v17
    v_mul_f32 v18, v8, v18
    v_mul_f32 v19, v8, v19
    v_mul_f32 v20, v8, v20
    v_mul_f32 v21, v8, v21
    v_mul_f32 v22, v8, v22
    v_mul_f32 v23, v8, v23
    v_mov_b32 v10, v9
    s_nop 0
    v_permlane32_swap_b32 v16, v20
    v_permlane32_swap_b32 v17, v21
    v_permlane32_swap_b32 v18, v22
    v_permlane32_swap_b32 v19, v23
    v_permlane32_swap_b32 v9, v10
    v_pk_add_f32 v[16:17], v[16:17], v[20:21]
    v_pk_add_f32 v[18:19], v[18:19], v[22:23]
    v_add_f32 v9, v9, v10
    v_mov_b32 v10, v9
    s_nop 0
    v_permlane16_swap_b32 v16, v18
    v_permlane16_swap_b32 v17, v19
    v_permlane16_swap_b32 v9, v10
    v_pk_add_f32 v[16:17], v[16:17], v[18:19]
    v_add_f32 v9, v9, v10
    s_nop 0
    v_add_f32_dpp v16, v16, v16 row_ror:4 row_mask:0xf bank_mask:0xf
    v_add_f32_dpp v17, v17, v17 row_ror:4 row_mask:0xf bank_mask:0xf
    v_add_f32_dpp v9, v9, v9 row_ror:4 row_mask:0xf bank_mask:0xf
    v_add_f32_dpp v16, v16, v16 row_ror:8 row_mask:0xf bank_mask:0xf
    v_add_f32_dpp v17, v17, v17 row_ror:8 row_mask:0xf bank_mask:0xf
    v_add_f32_dpp v9, v9, v9 row_ror:8 row_mask:0xf bank_mask:0xf
    v_rcp_f32 v9, v9
    s_nop 0
    v_mul_f32 v16, v9, v16
    v_mul_f32 v17, v9, v17
    v_cvt_pk_bf16_f32 v16, v16, v16
    v_cvt_pk_bf16_f32 v17, v17, v17
    ds_write_b64 v6, v[16:17]
    s_endpgm
    .p2align 12
L_roleA:
    s_setprio 2
    s_sub_u32 s40, s3, 2
    v_lshrrev_b32 v4, 4, v0
    v_and_b32 v5, 15, v0
    v_xor_b32 v6, v4, v5
    v_lshlrev_b32 v6, 4, v6
    s_lshl_b32 s42, s40, 14
    v_lshl_add_u32 v8, v5, 8, v6
    v_add_u32 v8, s42, v8
    v_xor_b32 v9, 64, v8
    v_xor_b32 v10, 128, v8
    v_xor_b32 v11, 192, v8
    v_lshlrev_b32 v7, 4, v5
    v_lshl_add_u32 v7, v4, 10, v7
    s_add_u32 s43, s42, 65536
    v_add_u32 v7, s43, v7
    v_lshrrev_b32 v12, 3, v5
    v_lshlrev_b32 v13, 8, v12
    v_lshl_add_u32 v13, v4, 4, v13
    v_add_u32 v13, 153088, v13
    s_lshl_b32 s44, s40, 2
    s_add_u32 s44, s44, 88
    s_waitcnt lgkmcnt(0)
    s_mov_b64 s[48:49], s[26:27]
    s_mov_b32 s50, 901376
    s_mov_b32 s51, 0x20000
    s_mov_b32 s78, 400000
L_sp_15:
    ds_read_b32 v14, v3 offset:12
    s_waitcnt lgkmcnt(0)
    v_readfirstlane_b32 s79, v14
    s_cmp_ge_u32 s79, 1
    s_cbranch_scc1 L_spd_16
    s_sleep 1
    s_sub_u32 s78, s78, 1
    s_cbranch_scc0 L_sp_15
L_spd_16:
    s_mov_b32 s78, 400000
L_sp_17:
    ds_read_b32 v14, v3 offset:32
    s_waitcnt lgkmcnt(0)
    v_readfirstlane_b32 s79, v14
    s_cmp_ge_u32 s79, 84
    s_cbranch_scc1 L_spd_18
    s_sleep 1
    s_sub_u32 s78, s78, 1
    s_cbranch_scc0 L_sp_17
L_spd_18:
    ds_read_b128 v[16:19], v13 offset:0
    ds_read_b128 v[20:23], v13 offset:64
    ds_read_b128 v[24:27], v13 offset:128
    ds_read_b128 v[28:31], v13 offset:192
    ds_read_b128 v[32:35], v8
    ds_read_b128 v[36:39], v9
    ds_read_b128 v[40:43], v10
    ds_read_b128 v[44:47], v11
    s_waitcnt lgkmcnt(3)
    v_mfma_f32_16x16x32_bf16 v[48:51], v[32:35], v[16:19], 0
    ds_read_b128 v[32:35], v8 offset:4096
    s_waitcnt lgkmcnt(3)
    v_mfma_f32_16x16x32_bf16 v[48:51], v[36:39], v[20:23], v[48:51]
    ds_read_b128 v[36:39], v9 offset:4096
    s_waitcnt lgkmcnt(3)
    v_mfma_f32_16x16x32_bf16 v[48:51], v[40:43], v[24:27], v[48:51]
    ds_read_b128 v[40:43], v10 offset:4096
    s_waitcnt lgkmcnt(3)
    v_mfma_f32_16x16x32_bf16 v[48:51], v[44:47], v[28:31], v[48:51]
    ds_read_b128 v[44:47], v11 offset:4096
    s_waitcnt lgkmcnt(3)
    v_mfma_f32_16x16x32_bf16 v[52:55], v[32:35], v[16:19], 0
    ds_read_b128 v[32:35], v8 offset:8192
    s_waitcnt lgkmcnt(3)
    v_mfma_f32_16x16x32_bf16 v[52:55], v[36:39], v[20:23], v[52:55]
    ds_read_b128 v[36:39], v9 offset:8192
    s_waitcnt lgkmcnt(3)
    v_mfma_f32_16x16x32_bf16 v[52:55], v[40:43], v[24:27], v[52:55]
    ds_read_b128 v[40:43], v10 offset:8192
    s_waitcnt lgkmcnt(3)
    v_mfma_f32_16x16x32_bf16 v[52:55], v[44:47], v[28:31], v[52:55]
    ds_read_b128 v[44:47], v11 offset:8192
    s_waitcnt lgkmcnt(3)
    v_mfma_f32_16x16x32_bf16 v[56:59], v[32:35], v[16:19], 0
    ds_read_b128 v[32:35], v8 offset:12288
    s_waitcnt lgkmcnt(3)
    v_mfma_f32_16x16x32_bf16 v[56:59], v[36:39], v[20:23], v[56:59]
    ds_read_b128 v[36:39], v9 offset:12288
    s_waitcnt lgkmcnt(3)
    v_mfma_f32_16x16x32_bf16 v[56:59], v[40:43], v[24:27], v[56:59]
    ds_read_b128 v[40:43], v10 offset:12288
    s_waitcnt lgkmcnt(3)
    v_mfma_f32_16x16x32_bf16 v[56:59], v[44:47], v[28:31], v[56:59]
    ds_read_b128 v[44:47], v11 offset:12288
    s_waitcnt lgkmcnt(3)
    v_mfma_f32_16x16x32_bf16 v[60:63], v[32:35], v[16:19], 0
    s_waitcnt lgkmcnt(2)
    v_mfma_f32_16x16x32_bf16 v[60:63], v[36:39], v[20:23], v[60:63]
    s_waitcnt lgkmcnt(1)
    v_mfma_f32_16x16x32_bf16 v[60:63], v[40:43], v[24:27], v[60:63]
    s_waitcnt lgkmcnt(0)
    v_mfma_f32_16x16x32_bf16 v[60:63], v[44:47], v[28:31], v[60:63]
    v_and_b32 v20, 1, v1
    v_lshlrev_b32 v20, 4, v20
    v_mov_b32 v21, 0xffff
    v_lshlrev_b32 v20, v20, v21
    v_lshrrev_b32 v21, 1, v1
    v_cmp_eq_u32 vcc, 0, v21
    s_nop 1
    v_cndmask_b32 v16, 0, v20, vcc
    v_cmp_eq_u32 vcc, 1, v21
    s_nop 1
    v_cndmask_b32 v17, 0, v20, vcc
    v_cmp_eq_u32 vcc, 2, v21
    s_nop 1
    v_cndmask_b32 v18, 0, v20, vcc
    v_cmp_eq_u32 vcc, 3, v21
    s_nop 1
    v_cndmask_b32 v19, 0, v20, vcc
    s_mov_b32 s43, 0x3db504f3
    v_cvt_pk_bf16_f32 v49, v48, v49
    v_lshlrev_b32 v48, 16, v49
    v_and_b32 v49, 0xffff0000, v49
    v_cvt_pk_bf16_f32 v51, v50, v51
    v_lshlrev_b32 v50, 16, v51
    v_and_b32 v51, 0xffff0000, v51
    v_cvt_pk_bf16_f32 v53, v52, v53
    v_lshlrev_b32 v52, 16, v53
    v_and_b32 v53, 0xffff0000, v53
    v_cvt_pk_bf16_f32 v55, v54, v55
    v_lshlrev_b32 v54, 16, v55
    v_and_b32 v55, 0xffff0000, v55
    v_cvt_pk_bf16_f32 v57, v56, v57
    v_lshlrev_b32 v56, 16, v57
    v_and_b32 v57, 0xffff0000, v57
    v_cvt_pk_bf16_f32 v59, v58, v59
    v_lshlrev_b32 v58, 16, v59
    v_and_b32 v59, 0xffff0000, v59
    v_cvt_pk_bf16_f32 v61, v60, v61
    v_lshlrev_b32 v60, 16, v61
    v_and_b32 v61, 0xffff0000, v61
    v_cvt_pk_bf16_f32 v63, v62, v63
    v_lshlrev_b32 v62, 16, v63
    v_and_b32 v63, 0xffff0000, v63
    v_mul_f32 v48, s43, v48
    v_mul_f32 v49, s43, v49
    v_mul_f32 v50, s43, v50
    v_mul_f32 v51, s43, v51
    v_mul_f32 v52, s43, v52
    v_mul_f32 v53, s43, v53
    v_mul_f32 v54, s43, v54
    v_mul_f32 v55, s43, v55
    v_mul_f32 v56, s43, v56
    v_mul_f32 v57, s43, v57
    v_mul_f32 v58, s43, v58
    v_mul_f32 v59, s43, v59
    v_mul_f32 v60, s43, v60
    v_mul_f32 v61, s43, v61
    v_mul_f32 v62, s43, v62
    v_mul_f32 v63, s43, v63
    v_cvt_pk_bf16_f32 v49, v48, v49
    v_lshlrev_b32 v48, 16, v49
    v_and_b32 v49, 0xffff0000, v49
    v_cvt_pk_bf16_f32 v51, v50, v51
    v_lshlrev_b32 v50, 16, v51
    v_and_b32 v51, 0xffff0000, v51
    v_cvt_pk_bf16_f32 v53, v52, v53
    v_lshlrev_b32 v52, 16, v53
    v_and_b32 v53, 0xffff0000, v53
    v_cvt_pk_bf16_f32 v55, v54, v55
    v_lshlrev_b32 v54, 16, v55
    v_and_b32 v55, 0xffff0000, v55
    v_cvt_pk_bf16_f32 v57, v56, v57
    v_lshlrev_b32 v56, 16, v57
    v_and_b32 v57, 0xffff0000, v57
    v_cvt_pk_bf16_f32 v59, v58, v59
    v_lshlrev_b32 v58, 16, v59
    v_and_b32 v59, 0xffff0000, v59
    v_cvt_pk_bf16_f32 v61, v60, v61
    v_lshlrev_b32 v60, 16, v61
    v_and_b32 v61, 0xffff0000, v61
    v_cvt_pk_bf16_f32 v63, v62, v63
    v_lshlrev_b32 v62, 16, v63
    v_and_b32 v63, 0xffff0000, v63
    v_max3_f32 v22, v48, v49, v50
    v_max3_f32 v22, v22, v51, v52
    v_max3_f32 v22, v22, v53, v54
    v_max3_f32 v22, v22, v55, v56
    v_max3_f32 v22, v22, v57, v58
    v_max3_f32 v22, v22, v59, v60
    v_max3_f32 v22, v22, v61, v62
    v_max_f32 v22, v22, v63
    v_mov_b32 v24, v22
    s_nop 1
    v_permlane16_swap_b32 v22, v24
    v_max_f32 v22, v22, v24
    v_mov_b32 v24, v22
    s_nop 1
    v_permlane32_swap_b32 v22, v24
    v_max_f32 v22, v22, v24
    s_mov_b32 s43, 0x3fb8aa3b
    v_sub_f32 v48, v48, v22
    v_sub_f32 v49, v49, v22
    v_sub_f32 v50, v50, v22
    v_sub_f32 v51, v51, v22
    v_sub_f32 v52, v52, v22
    v_sub_f32 v53, v53, v22
    v_sub_f32 v54, v54, v22
    v_sub_f32 v55, v55, v22
    v_sub_f32 v56, v56, v22
    v_sub_f32 v57, v57, v22
    v_sub_f32 v58, v58, v22
    v_sub_f32 v59, v59, v22
    v_sub_f32 v60, v60, v22
    v_sub_f32 v61, v61, v22
    v_sub_f32 v62, v62, v22
    v_sub_f32 v63, v63, v22
    v_mul_f32 v48, s43, v48
    v_mul_f32 v49, s43, v49
    v_mul_f32 v50, s43, v50
    v_mul_f32 v51, s43, v51
    v_mul_f32 v52, s43, v52
    v_mul_f32 v53, s43, v53
    v_mul_f32 v54, s43, v54
    v_mul_f32 v55, s43, v55
    v_mul_f32 v56, s43, v56
    v_mul_f32 v57, s43, v57
    v_mul_f32 v58, s43, v58
    v_mul_f32 v59, s43, v59
    v_mul_f32 v60, s43, v60
    v_mul_f32 v61, s43, v61
    v_mul_f32 v62, s43, v62
    v_mul_f32 v63, s43, v63
    v_exp_f32 v48, v48
    v_exp_f32 v49, v49
    v_exp_f32 v50, v50
    v_exp_f32 v51, v51
    v_exp_f32 v52, v52
    v_exp_f32 v53, v53
    v_exp_f32 v54, v54
    v_exp_f32 v55, v55
    v_exp_f32 v56, v56
    v_exp_f32 v57, v57
    v_exp_f32 v58, v58
    v_exp_f32 v59, v59
    v_exp_f32 v60, v60
    v_exp_f32 v61, v61
    v_exp_f32 v62, v62
    v_exp_f32 v63, v63
    v_add_f32 v23, v48, v49
    v_add_f32 v23, v23, v50
    v_add_f32 v23, v23, v51
    v_add_f32 v23, v23, v52
    v_add_f32 v23, v23, v53
    v_add_f32 v23, v23, v54
    v_add_f32 v23, v23, v55
    v_add_f32 v23, v23, v56
    v_add_f32 v23, v23, v57
    v_add_f32 v23, v23, v58
    v_add_f32 v23, v23, v59
    v_add_f32 v23, v23, v60
    v_add_f32 v23, v23, v61
    v_add_f32 v23, v23, v62
    v_add_f32 v23, v23, v63
    v_mov_b32 v24, v23
    s_nop 1
    v_permlane16_swap_b32 v23, v24
    v_add_f32 v23, v23, v24
    v_mov_b32 v24, v23
    s_nop 1
    v_permlane32_swap_b32 v23, v24
    v_add_f32 v23, v23, v24
    v_cvt_pk_bf16_f32 v48, v48, v48
    v_cvt_pk_bf16_f32 v49, v49, v49
    v_cvt_pk_bf16_f32 v50, v50, v50
    v_cvt_pk_bf16_f32 v51, v51, v51
    v_cvt_pk_bf16_f32 v52, v52, v52
    v_cvt_pk_bf16_f32 v53, v53, v53
    v_cvt_pk_bf16_f32 v54, v54, v54
    v_cvt_pk_bf16_f32 v55, v55, v55
    v_cvt_pk_bf16_f32 v56, v56, v56
    v_cvt_pk_bf16_f32 v57, v57, v57
    v_cvt_pk_bf16_f32 v58, v58, v58
    v_cvt_pk_bf16_f32 v59, v59, v59
    v_cvt_pk_bf16_f32 v60, v60, v60
    v_cvt_pk_bf16_f32 v61, v61, v61
    v_cvt_pk_bf16_f32 v62, v62, v62
    v_cvt_pk_bf16_f32 v63, v63, v63
    v_lshlrev_b32 v13, 3, v12
    v_add_u32 v13, 157696, v13
    s_lshl_b32 s52, s40, 4
    v_add_u32 v14, s52, v13
    s_mov_b64 exec, 0x101
    ds_write_b64 v14, v[22:23]
    s_mov_b64 exec, -1
    v_mov_b32 v9, 1
    s_mov_b64 exec, 1
    ds_add_rtn_u32 v9, v3, v9 offset:16
    s_mov_b64 exec, -1
    s_waitcnt lgkmcnt(0)
    v_readfirstlane_b32 s79, v9
    s_cmp_lg_u32 s79, 3
    s_cbranch_scc1 L_nostat
    ds_read_b64 v[24:25], v13 offset:0
    ds_read_b64 v[26:27], v13 offset:16
    ds_read_b64 v[28:29], v13 offset:32
    ds_read_b64 v[30:31], v13 offset:48
    s_waitcnt lgkmcnt(0)
    v_max3_f32 v22, v24, v26, v28
    v_max_f32 v22, v22, v30
    v_sub_f32 v32, v24, v22
    v_sub_f32 v33, v26, v22
    v_sub_f32 v34, v28, v22
    v_sub_f32 v35, v30, v22
    v_mul_f32 v32, s43, v32
    v_mul_f32 v33, s43, v33
    v_mul_f32 v34, s43, v34
    v_mul_f32 v35, s43, v35
    v_exp_f32 v32, v32
    v_exp_f32 v33, v33
    v_exp_f32 v34, v34
    v_exp_f32 v35, v35
    v_mul_f32 v23, v32, v25
    v_fmac_f32 v23, v33, v27
    v_fmac_f32 v23, v34, v29
    v_fmac_f32 v23, v35, v31
    v_lshlrev_b32 v14, 4, v12
    v_add_u32 v14, 157760, v14
    s_mov_b64 exec, 0x101
    ds_write_b128 v14, v[32:35]
    ds_write_b64 v13, v[22:23]
    s_mov_b64 exec, -1
L_nostat:
    v_and_b32 v64, v48, v16
    v_and_b32 v65, v48, v17
    v_and_b32 v66, v48, v18
    v_and_b32 v67, v48, v19
    v_and_b32 v68, v49, v16
    v_and_b32 v69, v49, v17
    v_and_b32 v70, v49, v18
    v_and_b32 v71, v49, v19
    v_and_b32 v72, v50, v16
    v_and_b32 v73, v50, v17
    v_and_b32 v74, v50, v18
    v_and_b32 v75, v50, v19
    v_and_b32 v76, v51, v16
    v_and_b32 v77, v51, v17
    v_and_b32 v78, v51, v18
    v_and_b32 v79, v51, v19
    v_and_b32 v80, v52, v16
    v_and_b32 v81, v52, v17
    v_and_b32 v82, v52, v18
    v_and_b32 v83, v52, v19
    v_and_b32 v84, v53, v16
    v_and_b32 v85, v53, v17
    v_and_b32 v86, v53, v18
    v_and_b32 v87, v53, v19
    v_and_b32 v88, v54, v16
    v_and_b32 v89, v54, v17
    v_and_b32 v90, v54, v18
    v_and_b32 v91, v54, v19
    v_and_b32 v92, v55, v16
    v_and_b32 v93, v55, v17
    v_and_b32 v94, v55, v18
    v_and_b32 v95, v55, v19
    v_and_b32 v96, v56, v16
    v_and_b32 v97, v56, v17
    v_and_b32 v98, v56, v18
    v_and_b32 v99, v56, v19
    v_and_b32 v100, v57, v16
    v_and_b32 v101, v57, v17
    v_and_b32 v102, v57, v18
    v_and_b32 v103, v57, v19
    v_and_b32 v104, v58, v16
    v_and_b32 v105, v58, v17
    v_and_b32 v106, v58, v18
    v_and_b32 v107, v58, v19
    v_and_b32 v108, v59, v16
    v_and_b32 v109, v59, v17
    v_and_b32 v110, v59, v18
    v_and_b32 v111, v59, v19
    v_and_b32 v112, v60, v16
    v_and_b32 v113, v60, v17
    v_and_b32 v114, v60, v18
    v_and_b32 v115, v60, v19
    v_and_b32 v116, v61, v16
    v_and_b32 v117, v61, v17
    v_and_b32 v118, v61, v18
    v_and_b32 v119, v61, v19
    v_and_b32 v120, v62, v16
    v_and_b32 v121, v62, v17
    v_and_b32 v122, v62, v18
    v_and_b32 v123, v62, v19
    v_and_b32 v124, v63, v16
    v_and_b32 v125, v63, v17
    v_and_b32 v126, v63, v18
    v_and_b32 v127, v63, v19
    v_lshlrev_b32 v13, 4, v0
    v_add_u32 v13, 153600, v13
    s_lshl_b32 s52, s40, 10
    v_add_u32 v11, s52, v13
    v_lshrrev_b32 v15, 5, v0
    v_lshlrev_b32 v12, 8, v15
    v_lshl_add_u32 v12, v5, 4, v12
    v_and_b32 v10, 1, v4
    v_lshl_add_u32 v12, v10, 3, v12
    v_lshlrev_b32 v15, 4, v15
    v_add_u32 v15, 157760, v15
    v_mov_b32 v10, 157696
    v_mov_b32 v8, 0
    s_mov_b32 s78, 400000
L_sp_19:
    ds_read_b32 v14, v3 offset:32
    s_waitcnt lgkmcnt(0)
    v_readfirstlane_b32 s79, v14
    s_cmp_ge_u32 s79, s44
    s_cbranch_scc1 L_spd_20
    s_sleep 1
    s_sub_u32 s78, s78, 1
    s_cbranch_scc0 L_sp_19
L_spd_20:
    ds_read_b128 v[20:23], v7 offset:0
    ds_read_b128 v[24:27], v7 offset:256
    ds_read_b128 v[28:31], v7 offset:512
    ds_read_b128 v[32:35], v7 offset:768
    s_add_u32 s44, s44, 16
    s_waitcnt lgkmcnt(3)
    v_mfma_f32_16x16x32_bf16 v[44:47], v[64:67], v[20:23], 0
    s_waitcnt lgkmcnt(2)
    v_mfma_f32_16x16x32_bf16 v[44:47], v[68:71], v[24:27], v[44:47]
    s_waitcnt lgkmcnt(1)
    v_mfma_f32_16x16x32_bf16 v[44:47], v[72:75], v[28:31], v[44:47]
    s_waitcnt lgkmcnt(0)
    v_mfma_f32_16x16x32_bf16 v[44:47], v[76:79], v[32:35], v[44:47]
    s_mov_b32 s78, 400000
L_sp_21:
    ds_read_b32 v14, v3 offset:32
    s_waitcnt lgkmcnt(0)
    v_readfirstlane_b32 s79, v14
    s_cmp_ge_u32 s79, s44
    s_cbranch_scc1 L_spd_22
    s_sleep 1
    s_sub_u32 s78, s78, 1
    s_cbranch_scc0 L_sp_21
L_spd_22:
    ds_read_b128 v[20:23], v7 offset:4096
    ds_read_b128 v[24:27], v7 offset:4352
    ds_read_b128 v[28:31], v7 offset:4608
    ds_read_b128 v[32:35], v7 offset:4864
    s_add_u32 s44, s44, 16
    s_waitcnt lgkmcnt(3)
    v_mfma_f32_16x16x32_bf16 v[44:47], v[80:83], v[20:23], v[44:47]
    s_waitcnt lgkmcnt(2)
    v_mfma_f32_16x16x32_bf16 v[44:47], v[84:87], v[24:27], v[44:47]
    s_waitcnt lgkmcnt(1)
    v_mfma_f32_16x16x32_bf16 v[44:47], v[88:91], v[28:31], v[44:47]
    s_waitcnt lgkmcnt(0)
    v_mfma_f32_16x16x32_bf16 v[44:47], v[92:95], v[32:35], v[44:47]
    s_mov_b32 s78, 400000
L_sp_23:
    ds_read_b32 v14, v3 offset:32
    s_waitcnt lgkmcnt(0)
    v_readfirstlane_b32 s79, v14
    s_cmp_ge_u32 s79, s44
    s_cbranch_scc1 L_spd_24
    s_sleep 1
    s_sub_u32 s78, s78, 1
    s_cbranch_scc0 L_sp_23
L_spd_24:
    ds_read_b128 v[20:23], v7 offset:8192
    ds_read_b128 v[24:27], v7 offset:8448
    ds_read_b128 v[28:31], v7 offset:8704
    ds_read_b128 v[32:35], v7 offset:8960
    s_add_u32 s44, s44, 16
    s_waitcnt lgkmcnt(3)
    v_mfma_f32_16x16x32_bf16 v[44:47], v[96:99], v[20:23], v[44:47]
    s_waitcnt lgkmcnt(2)
    v_mfma_f32_16x16x32_bf16 v[44:47], v[100:103], v[24:27], v[44:47]
    s_waitcnt lgkmcnt(1)
    v_mfma_f32_16x16x32_bf16 v[44:47], v[104:107], v[28:31], v[44:47]
    s_waitcnt lgkmcnt(0)
    v_mfma_f32_16x16x32_bf16 v[44:47], v[108:111], v[32:35], v[44:47]
    s_mov_b32 s78, 400000
L_sp_25:
    ds_read_b32 v14, v3 offset:32
    s_waitcnt lgkmcnt(0)
    v_readfirstlane_b32 s79, v14
    s_cmp_ge_u32 s79, s44
    s_cbranch_scc1 L_spd_26
    s_sleep 1
    s_sub_u32 s78, s78, 1
    s_cbranch_scc0 L_sp_25
L_spd_26:
    ds_read_b128 v[20:23], v7 offset:12288
    ds_read_b128 v[24:27], v7 offset:12544
    ds_read_b128 v[28:31], v7 offset:12800
    ds_read_b128 v[32:35], v7 offset:13056
    s_waitcnt lgkmcnt(3)
    v_mfma_f32_16x16x32_bf16 v[44:47], v[112:115], v[20:23], v[44:47]
    s_waitcnt lgkmcnt(2)
    v_mfma_f32_16x16x32_bf16 v[44:47], v[116:119], v[24:27], v[44:47]
    s_waitcnt lgkmcnt(1)
    v_mfma_f32_16x16x32_bf16 v[44:47], v[120:123], v[28:31], v[44:47]
    s_waitcnt lgkmcnt(0)
    v_mfma_f32_16x16x32_bf16 v[44:47], v[124:127], v[32:35], v[44:47]
    s_nop 7
    ds_write_b128 v11, v[44:47]
    v_mov_b32 v9, 1
    s_mov_b64 exec, 1
    ds_add_rtn_u32 v9, v3, v9 offset:20
    s_mov_b64 exec, -1
    s_waitcnt lgkmcnt(0)
    v_readfirstlane_b32 s79, v9
    s_cmp_lg_u32 s79, 3
    s_cbranch_scc1 L_nopub
    s_mov_b32 s78, 400000
L_sp_27:
    ds_read_b32 v9, v3 offset:8
    s_waitcnt lgkmcnt(0)
    v_readfirstlane_b32 s79, v9
    s_cmp_ge_u32 s79, 1
    s_cbranch_scc1 L_spd_28
    s_sleep 1
    s_sub_u32 s78, s78, 1
    s_cbranch_scc0 L_sp_27
L_spd_28:
    ds_read_b128 v[16:19], v15
    ds_read_b128 v[20:23], v13 offset:0
    ds_read_b128 v[24:27], v13 offset:1024
    ds_read_b128 v[28:31], v13 offset:2048
    ds_read_b128 v[32:35], v13 offset:3072
    ds_read_b128 v[40:43], v10
    s_waitcnt lgkmcnt(4)
    v_mul_f32 v36, v16, v20
    v_mul_f32 v37, v16, v21
    v_mul_f32 v38, v16, v22
    v_mul_f32 v39, v16, v23
    s_waitcnt lgkmcnt(3)
    v_fmac_f32 v36, v17, v24
    v_fmac_f32 v37, v17, v25
    v_fmac_f32 v38, v17, v26
    v_fmac_f32 v39, v17, v27
    s_waitcnt lgkmcnt(2)
    v_fmac_f32 v36, v18, v28
    v_fmac_f32 v37, v18, v29
    v_fmac_f32 v38, v18, v30
    v_fmac_f32 v39, v18, v31
    s_waitcnt lgkmcnt(1)
    v_fmac_f32 v36, v19, v32
    v_fmac_f32 v37, v19, v33
    v_fmac_f32 v38, v19, v34
    v_fmac_f32 v39, v19, v35
    v_cvt_pk_bf16_f32 v36, v36, v37
    v_cvt_pk_bf16_f32 v37, v38, v39
    s_waitcnt lgkmcnt(0)
    s_cmp_eq_u32 s79, 1
    s_cbranch_scc0 L_ms_29
    buffer_store_dwordx2 v[36:37], v12, s[48:51], s74 offen offset:640
    buffer_store_dwordx4 v[40:43], v8, s[48:51], s74 offen offset:528
L_me_30:
L_nopub:
    s_cmp_lt_u32 s40, 2
    s_cbranch_scc1 L_red
    s_endpgm
L_ms_29:
    buffer_store_dwordx2 v[36:37], v12, s[48:51], s74 offen offset:640 sc1
    buffer_store_dwordx4 v[40:43], v8, s[48:51], s74 offen offset:528 sc1
    s_branch L_me_30
L_goglobal:
    s_mov_b32 s62, 2
    s_mov_b32 s78, 400000
L_sp_31:
    ds_read_b32 v5, v3 offset:4
    s_waitcnt lgkmcnt(0)
    v_readfirstlane_b32 s79, v5
    s_cmp_ge_u32 s79, 1
    s_cbranch_scc1 L_spd_32
    s_sleep 1
    s_sub_u32 s78, s78, 1
    s_cbranch_scc0 L_sp_31
L_spd_32:
    v_mov_b32 v120, -1
    v_mov_b32 v121, -1
    v_mov_b32 v122, -1
    v_mov_b32 v123, -1
    buffer_store_dwordx4 v[120:123], v4, s[44:47], s74 offen offset:528 sc1
    buffer_store_dwordx4 v[120:123], v4, s[44:47], s74 offen offset:1552 sc1
    s_mov_b64 exec, 0x7fffff
    buffer_store_dwordx4 v[120:123], v4, s[44:47], s74 offen offset:2576 sc1
    s_mov_b64 exec, -1
    s_mov_b32 exec_hi, 0
    buffer_store_dwordx4 v[8:11], v6, s[44:47], s74 offen offset:0 sc1
    s_mov_b64 exec, -1
    s_or_b32 s65, s61, 0x100
    s_waitcnt vmcnt(0)
    v_mov_b32 v124, s65
    v_mov_b32 v125, s60
    s_mov_b64 exec, 1
    buffer_store_dwordx2 v[124:125], v4, s[44:47], s74 offen offset:512 sc1
    s_mov_b64 exec, -1
    s_branch L_qpoll
L_Gw2:
    v_and_b32 v4, 15, v0
    v_min_u32 v4, 8, v4
    s_and_b32 s42, s31, 15
    s_mul_i32 s42, s42, 72
    v_lshl_add_u32 v5, v4, 3, s42
    v_add_u32 v6, 22912, v5
    v_cmp_gt_u32 vcc, 640, v5
    v_and_b32 v7, 1, v24
    v_lshrrev_b32 v8, 1, v24
    v_cndmask_b32 v5, v6, v5, vcc
    v_lshl_add_u32 v9, v8, 4, v7
    v_mul_u32_u24 v9, 2944, v9
    v_add_u32 v5, v5, v9
    v_lshlrev_b32 v6, 4, v4
    v_lshl_add_u32 v6, v7, 3, v6
    v_lshl_add_u32 v6, v8, 2, v6
    v_add_u32 v6, 157792, v6
    s_add_u32 s48, s75, 0
    s_add_u32 s49, s75, 5888
    s_add_u32 s50, s75, 11776
    s_add_u32 s51, s75, 17664
    s_mov_b32 s78, 400000
L_sp_33:
    ds_read_b32 v7, v3 offset:36
    s_waitcnt lgkmcnt(0)
    v_readfirstlane_b32 s79, v7
    s_cmp_ge_u32 s79, 6
    s_cbranch_scc1 L_spd_34
    s_sub_u32 s78, s78, 1
    s_cbranch_scc0 L_sp_33
L_spd_34:
L_hpoll:
    buffer_load_dwordx2 v[8:9], v5, s[44:47], s48 offen offset:1152 sc1
    buffer_load_dwordx2 v[10:11], v5, s[44:47], s49 offen offset:1152 sc1
    buffer_load_dwordx2 v[12:13], v5, s[44:47], s50 offen offset:1152 sc1
    buffer_load_dwordx2 v[14:15], v5, s[44:47], s51 offen offset:1152 sc1
    v_mov_b32 v7, 1
    ds_write_b32 v3, v7 offset:28
    s_waitcnt vmcnt(0)
    v_max3_u32 v7, v8, v9, v10
    v_max3_u32 v7, v7, v11, v12
    v_max3_u32 v7, v7, v13, v14
    v_max_u32 v7, v7, v15
    v_cmp_eq_u32 vcc, -1, v7
    s_cbranch_vccz L_ok_35
    s_sub_u32 s77, s77, 1
    s_cbranch_scc0 L_hpoll
L_ok_35:
    v_lshlrev_b32 v16, 16, v8
    v_and_b32 v17, 0xffff0000, v8
    v_lshlrev_b32 v18, 16, v9
    v_and_b32 v19, 0xffff0000, v9
    v_lshlrev_b32 v20, 16, v10
    v_and_b32 v21, 0xffff0000, v10
    v_lshlrev_b32 v22, 16, v11
    v_and_b32 v23, 0xffff0000, v11
    v_lshlrev_b32 v24, 16, v12
    v_and_b32 v25, 0xffff0000, v12
    v_lshlrev_b32 v26, 16, v13
    v_and_b32 v27, 0xffff0000, v13
    v_lshlrev_b32 v28, 16, v14
    v_and_b32 v29, 0xffff0000, v14
    v_lshlrev_b32 v30, 16, v15
    v_and_b32 v31, 0xffff0000, v15
    v_pk_add_f32 v[16:17], v[16:17], v[20:21]
    v_pk_add_f32 v[18:19], v[18:19], v[22:23]
    v_pk_add_f32 v[24:25], v[24:25], v[28:29]
    v_pk_add_f32 v[26:27], v[26:27], v[30:31]
    v_pk_add_f32 v[16:17], v[16:17], v[24:25]
    v_pk_add_f32 v[18:19], v[18:19], v[26:27]
    s_nop 1
    v_permlane16_swap_b32 v16, v18
    v_permlane16_swap_b32 v17, v19
    v_pk_add_f32 v[8:9], v[16:17], v[18:19]
    s_nop 1
    v_permlane32_swap_b32 v8, v9
    v_cvt_pk_bf16_f32 v9, v8, v9
    v_lshlrev_b32 v8, 16, v9
    v_and_b32 v9, 0xffff0000, v9
    v_mul_f32 v10, 0xbfb8aa3b, v8
    v_exp_f32 v10, v10
    s_nop 0
    v_add_f32 v10, 1.0, v10
    v_rcp_f32 v10, v10
    s_nop 0
    v_mul_f32 v8, v8, v10
    v_cvt_pk_bf16_f32 v8, v8, v8
    v_and_b32 v8, 0xffff0000, v8
    v_mul_f32 v8, v8, v9
    v_cvt_pk_bf16_f32 v8, v8, v8
    ds_write_b32 v6, v8
    s_endpgm
    .p2align 12
L_roleF:
    s_setprio 1
    s_sub_u32 s40, s3, 6
    s_lshr_b32 s41, s29, 3
    s_mul_i32 s41, s41, 5
    s_add_u32 s41, s41, s40
    s_lshr_b32 s42, s28, 1
    s_mul_i32 s42, s42, 9
    s_add_u32 s42, s42, s41
    s_mul_i32 s44, s30, 663552
    s_lshl_b32 s45, s42, 7
    s_add_u32 s44, s44, s45
    v_mul_u32_u24 v6, 9216, v2
    v_lshl_add_u32 v6, v1, 4, v6
    s_mov_b32 s34, 5308416
    s_mov_b32 s35, 0x20000
    s_bitcmp1_b32 s28, 0
    s_waitcnt lgkmcnt(0)
    s_cselect_b64 s[32:33], s[18:19], s[16:17]
    s_cmp_ge_u32 s41, 9
    s_cbranch_scc1 L_Fidle
    s_mov_b64 s[36:37], s[26:27]
    s_mov_b32 s38, 901376
    s_mov_b32 s39, 0x20000
    v_and_b32 v4, 1, v1
    v_lshlrev_b32 v4, 4, v4
    v_mov_b32 v5, 0xffff
    v_lshlrev_b32 v4, v4, v5
    v_lshrrev_b32 v5, 1, v1
    v_cmp_eq_u32 vcc, 0, v5
    s_nop 1
    v_cndmask_b32 v28, 0, v4, vcc
    v_cmp_eq_u32 vcc, 1, v5
    s_nop 1
    v_cndmask_b32 v29, 0, v4, vcc
    v_cmp_eq_u32 vcc, 2, v5
    s_nop 1
    v_cndmask_b32 v30, 0, v4, vcc
    v_cmp_eq_u32 vcc, 3, v5
    s_nop 1
    v_cndmask_b32 v31, 0, v4, vcc
    s_mov_b32 s78, 400000
L_sp_36:
    ds_read_b32 v5, v3 offset:0
    s_waitcnt lgkmcnt(0)
    v_readfirstlane_b32 s79, v5
    s_cmp_ge_u32 s79, 1
    s_cbranch_scc1 L_spd_37
    s_sleep 2
    s_sub_u32 s78, s78, 1
    s_cbranch_scc0 L_sp_36
L_spd_37:
    s_mul_i32 s45, s30, 288
    s_add_u32 s45, s45, 150784
    v_lshl_add_u32 v4, v2, 2, s45
    ds_read2_b32 v[8:9], v4 offset0:0 offset1:8
    ds_read2_b32 v[10:11], v4 offset0:16 offset1:24
    ds_read2_b32 v[12:13], v4 offset0:32 offset1:40
    ds_read2_b32 v[14:15], v4 offset0:48 offset1:56
    ds_read_b32 v16, v4 offset:256
    v_lshlrev_b32 v7, 4, v1
    v_bfe_u32 v5, v0, 4, 1
    v_lshl_add_u32 v7, v5, 3, v7
    v_lshrrev_b32 v5, 5, v0
    v_lshl_add_u32 v7, v5, 2, v7
    s_lshl_b32 s45, s40, 7
    s_add_u32 s45, s45, s74
    s_mul_i32 s46, s40, 6
    s_add_u32 s46, s46, 124
    s_min_u32 s46, s46, 148
    s_waitcnt lgkmcnt(0)
    v_and_b32 v68, v8, v28
    v_and_b32 v69, v8, v29
    v_and_b32 v70, v8, v30
    v_and_b32 v71, v8, v31
    v_and_b32 v72, v9, v28
    v_and_b32 v73, v9, v29
    v_and_b32 v74, v9, v30
    v_and_b32 v75, v9, v31
    v_and_b32 v76, v10, v28
    v_and_b32 v77, v10, v29
    v_and_b32 v78, v10, v30
    v_and_b32 v79, v10, v31
    v_and_b32 v80, v11, v28
    v_and_b32 v81, v11, v29
    v_and_b32 v82, v11, v30
    v_and_b32 v83, v11, v31
    v_and_b32 v84, v12, v28
    v_and_b32 v85, v12, v29
    v_and_b32 v86, v12, v30
    v_and_b32 v87, v12, v31
    v_and_b32 v88, v13, v28
    v_and_b32 v89, v13, v29
    v_and_b32 v90, v13, v30
    v_and_b32 v91, v13, v31
    v_and_b32 v92, v14, v28
    v_and_b32 v93, v14, v29
    v_and_b32 v94, v14, v30
    v_and_b32 v95, v14, v31
    v_and_b32 v96, v15, v28
    v_and_b32 v97, v15, v29
    v_and_b32 v98, v15, v30
    v_and_b32 v99, v15, v31
    v_and_b32 v100, v16, v28
    v_and_b32 v101, v16, v29
    v_and_b32 v102, v16, v30
    v_and_b32 v103, v16, v31
    s_mov_b32 s78, 400000
L_sp_38:
    ds_read_b32 v5, v3 offset:32
    s_waitcnt lgkmcnt(0)
    v_readfirstlane_b32 s79, v5
    s_cmp_ge_u32 s79, s46
    s_cbranch_scc1 L_spd_39
    s_sleep 1
    s_sub_u32 s78, s78, 1
    s_cbranch_scc0 L_sp_38
L_spd_39:
    buffer_load_dwordx4 v[32:35], v6, s[32:35], s44 offen nt
    s_add_u32 s44, s44, 73728
    buffer_load_dwordx4 v[36:39], v6, s[32:35], s44 offen nt
    s_add_u32 s44, s44, 73728
    buffer_load_dwordx4 v[40:43], v6, s[32:35], s44 offen nt
    s_add_u32 s44, s44, 73728
    buffer_load_dwordx4 v[44:47], v6, s[32:35], s44 offen nt
    s_add_u32 s44, s44, 73728
    buffer_load_dwordx4 v[48:51], v6, s[32:35], s44 offen nt
    s_add_u32 s44, s44, 73728
    buffer_load_dwordx4 v[52:55], v6, s[32:35], s44 offen nt
    s_add_u32 s44, s44, 73728
    buffer_load_dwordx4 v[56:59], v6, s[32:35], s44 offen nt
    s_add_u32 s44, s44, 73728
    buffer_load_dwordx4 v[60:63], v6, s[32:35], s44 offen nt
    s_add_u32 s44, s44, 73728
    buffer_load_dwordx4 v[64:67], v6, s[32:35], s44 offen nt
    v_mov_b32 v5, 1
    s_mov_b64 exec, 1
    ds_add_u32 v3, v5 offset:44
    s_mov_b64 exec, -1
    s_setprio 3
    s_mov_b32 s78, 400000
L_sp_40:
    ds_read_b32 v5, v3 offset:8
    s_waitcnt lgkmcnt(0)
    v_readfirstlane_b32 s79, v5
    s_cmp_ge_u32 s79, 1
    s_cbranch_scc1 L_spd_41
    s_sleep 1
    s_sub_u32 s78, s78, 1
    s_cbranch_scc0 L_sp_40
L_spd_41:
    s_waitcnt vmcnt(8)
    v_mfma_f32_16x16x32_bf16 v[20:23], v[68:71], v[32:35], 0
    s_waitcnt vmcnt(7)
    v_mfma_f32_16x16x32_bf16 v[20:23], v[72:75], v[36:39], v[20:23]
    s_waitcnt vmcnt(6)
    v_mfma_f32_16x16x32_bf16 v[20:23], v[76:79], v[40:43], v[20:23]
    s_waitcnt vmcnt(5)
    v_mfma_f32_16x16x32_bf16 v[20:23], v[80:83], v[44:47], v[20:23]
    s_waitcnt vmcnt(4)
    v_mfma_f32_16x16x32_bf16 v[20:23], v[84:87], v[48:51], v[20:23]
    s_waitcnt vmcnt(3)
    v_mfma_f32_16x16x32_bf16 v[20:23], v[88:91], v[52:55], v[20:23]
    s_waitcnt vmcnt(2)
    v_mfma_f32_16x16x32_bf16 v[20:23], v[92:95], v[56:59], v[20:23]
    s_waitcnt vmcnt(1)
    v_mfma_f32_16x16x32_bf16 v[20:23], v[96:99], v[60:63], v[20:23]
    s_waitcnt vmcnt(0)
    v_mfma_f32_16x16x32_bf16 v[20:23], v[100:103], v[64:67], v[20:23]
    s_nop 7
    v_permlane32_swap_b32 v20, v22
    v_permlane32_swap_b32 v21, v23
    s_nop 0
    v_add_f32_dpp v24, v22, v20 row_ror:8 row_mask:0xf bank_mask:0xf
    v_add_f32_dpp v25, v23, v21 row_ror:8 row_mask:0xf bank_mask:0xf
    v_cvt_pk_bf16_f32 v24, v24, v25
    s_mov_b32 exec_lo, 0x00ff00ff
    s_mov_b32 exec_hi, 0x00ff00ff
    s_cmp_eq_u32 s79, 1
    s_cbranch_scc0 L_ms_42
    buffer_store_dword v24, v7, s[36:39], s45 offen offset:1152
L_me_43:
L_Fidle:
    v_mov_b32 v5, 1
    s_mov_b64 exec, 1
    ds_add_u32 v3, v5 offset:36
    s_endpgm
L_roleO:
    s_sub_u32 s40, s3, 11
    s_mov_b32 s38, 901376
    s_mov_b32 s39, 0x20000
    s_waitcnt lgkmcnt(0)
    s_mov_b64 s[36:37], s[26:27]
    s_cmp_lg_u32 s40, 0
    s_cbranch_scc1 L_Onoclr
    s_setprio 3
    s_load_dword s60, s[26:27], 901120
    v_lshlrev_b32 v4, 7, v0
    s_mov_b64 exec, 0x7fffff
    buffer_load_dword v126, v4, s[36:39], s74 offen
    s_mov_b64 exec, -1
    s_getreg_b32 s61, hwreg(HW_REG_XCC_ID, 0, 4)
    v_lshlrev_b32 v4, 4, v0
    v_mov_b32 v8, -1
    v_mov_b32 v9, -1
    v_mov_b32 v10, -1
    v_mov_b32 v11, -1
    buffer_store_dwordx4 v[8:11], v4, s[36:39], s74 offen offset:528
    buffer_store_dwordx4 v[8:11], v4, s[36:39], s74 offen offset:1552
    s_mov_b64 exec, 0x7fffff
    buffer_store_dwordx4 v[8:11], v4, s[36:39], s74 offen offset:2576
    s_mov_b64 exec, -1
    s_waitcnt lgkmcnt(0)
    s_add_u32 s60, s60, 1
    v_mov_b32 v5, s60
    ds_write_b32 v3, v5 offset:40
    s_cmp_lt_u32 s2, 80
    s_cselect_b32 s42, 1, 0
    s_mov_b32 s78, 400000
L_sp_44:
    ds_read_b32 v6, v3 offset:48
    s_waitcnt lgkmcnt(0)
    v_readfirstlane_b32 s79, v6
    s_cmp_ge_u32 s79, s42
    s_cbranch_scc1 L_spd_45
    s_sleep 1
    s_sub_u32 s78, s78, 1
    s_cbranch_scc0 L_sp_44
L_spd_45:
    s_and_b32 s79, s79, 2
    s_lshl_b32 s79, s79, 3
    s_or_b32 s61, s61, s79
    s_waitcnt vmcnt(0)
    v_mov_b32 v12, s61
    v_mov_b32 v13, s60
    s_mov_b64 exec, 1
    buffer_store_dwordx2 v[12:13], v4, s[36:39], s74 offen offset:512
    s_mov_b64 exec, -1
    s_waitcnt vmcnt(0)
    v_mov_b32 v6, 1
    ds_write_b32 v3, v6 offset:4
    s_setprio 0
    s_branch L_Ogo
L_Onoclr:
L_Ogo:
    v_and_b32 v4, 1, v1
    v_lshlrev_b32 v4, 4, v4
    v_mov_b32 v5, 0xffff
    v_lshlrev_b32 v4, v4, v5
    v_lshrrev_b32 v5, 1, v1
    v_cmp_eq_u32 vcc, 0, v5
    s_nop 1
    v_cndmask_b32 v60, 0, v4, vcc
    v_cmp_eq_u32 vcc, 1, v5
    s_nop 1
    v_cndmask_b32 v61, 0, v4, vcc
    v_cmp_eq_u32 vcc, 2, v5
    s_nop 1
    v_cndmask_b32 v62, 0, v4, vcc
    v_cmp_eq_u32 vcc, 3, v5
    s_nop 1
    v_cndmask_b32 v63, 0, v4, vcc
    s_cmp_ge_u32 s29, 8
    s_cselect_b64 s[32:33], s[20:21], s[12:13]
    s_cselect_b32 s41, 36, 32
    s_mul_i32 s41, s41, 1152
    s_lshl_b32 s34, s41, 7
    s_mov_b32 s35, 0x20000
    s_mul_i32 s41, s41, s31
    s_mul_i32 s42, s40, 384
    s_add_u32 s41, s41, s42
    s_add_u32 s50, s74, s42
    v_mul_u32_u24 v6, 4608, v2
    v_lshl_add_u32 v6, v1, 4, v6
    v_lshlrev_b32 v26, 4, v1
    v_bfe_u32 v5, v0, 4, 1
    v_lshl_add_u32 v26, v5, 3, v26
    v_lshrrev_b32 v5, 5, v0
    v_lshl_add_u32 v26, v5, 2, v26
    v_lshrrev_b32 v4, 4, v0
    v_mul_u32_u24 v25, 1152, v4
    v_lshl_add_u32 v25, v1, 4, v25
    v_and_b32 v5, 8, v0
    v_lshl_add_u32 v25, v5, 27, v25
    s_add_u32 s48, s41, 36864
    v_lshlrev_b32 v7, 4, v2
    v_add_u32 v7, 157792, v7
    s_cmp_ge_u32 s29, 8
    s_cselect_b32 s48, s48, 0x40000000
    s_cselect_b32 s43, 128, 0
    s_add_u32 s43, s43, 157792
    v_lshl_add_u32 v4, v4, 2, s43
    s_mov_b32 s42, 0
    s_cmp_eq_u32 s40, 1
    s_cselect_b32 s42, 5, s42
    s_cmp_eq_u32 s40, 2
    s_cselect_b32 s42, 6, s42
    s_lshr_b32 s43, s40, 1
    s_mov_b32 s78, 400000
L_sp_46:
    ds_read_b32 v5, v3 offset:8
    s_waitcnt lgkmcnt(0)
    v_readfirstlane_b32 s79, v5
    s_cmp_ge_u32 s79, 1
    s_cbranch_scc1 L_spd_47
    s_sleep 2
    s_sub_u32 s78, s78, 1
    s_cbranch_scc0 L_sp_46
L_spd_47:
    s_lshr_b32 s44, s29, 3
    s_sub_u32 s44, 5, s44
    s_mov_b32 s78, 400000
L_sp_48:
    ds_read_b32 v5, v3 offset:44
    s_waitcnt lgkmcnt(0)
    v_readfirstlane_b32 s79, v5
    s_cmp_ge_u32 s79, s44
    s_cbranch_scc1 L_spd_49
    s_sleep 1
    s_sub_u32 s78, s78, 1
    s_cbranch_scc0 L_sp_48
L_spd_49:
    s_mov_b32 s78, 400000
L_sp_50:
    ds_read_b32 v5, v3 offset:36
    s_waitcnt lgkmcnt(0)
    v_readfirstlane_b32 s79, v5
    s_cmp_ge_u32 s79, s42
    s_cbranch_scc1 L_spd_51
    s_sleep 1
    s_sub_u32 s78, s78, 1
    s_cbranch_scc0 L_sp_50
L_spd_51:
    s_mov_b32 s78, 400000
L_sp_52:
    ds_read_b32 v5, v3 offset:28
    s_waitcnt lgkmcnt(0)
    v_readfirstlane_b32 s79, v5
    s_cmp_ge_u32 s79, s43
    s_cbranch_scc1 L_spd_53
    s_sub_u32 s78, s78, 1
    s_cbranch_scc0 L_sp_52
L_spd_53:
    ds_read_b32 v27, v3 offset:8
    buffer_load_dwordx4 v[112:115], v25, s[32:35], s48 offen offset:0 nt
    buffer_load_dwordx4 v[116:119], v25, s[32:35], s48 offen offset:128 nt
    buffer_load_dwordx4 v[120:123], v25, s[32:35], s48 offen offset:256 nt
    buffer_load_dwordx4 v[64:67], v6, s[32:35], s41 offen offset:0 nt
    buffer_load_dwordx4 v[68:71], v6, s[32:35], s41 offen offset:128 nt
    buffer_load_dwordx4 v[72:75], v6, s[32:35], s41 offen offset:256 nt
    buffer_load_dwordx4 v[76:79], v6, s[32:35], s41 offen offset:1152 nt
    buffer_load_dwordx4 v[80:83], v6, s[32:35], s41 offen offset:1280 nt
    buffer_load_dwordx4 v[84:87], v6, s[32:35], s41 offen offset:1408 nt
    buffer_load_dwordx4 v[88:91], v6, s[32:35], s41 offen offset:2304 nt
    buffer_load_dwordx4 v[92:95], v6, s[32:35], s41 offen offset:2432 nt
    buffer_load_dwordx4 v[96:99], v6, s[32:35], s41 offen offset:2560 nt
    buffer_load_dwordx4 v[100:103], v6, s[32:35], s41 offen offset:3456 nt
    buffer_load_dwordx4 v[104:107], v6, s[32:35], s41 offen offset:3584 nt
    buffer_load_dwordx4 v[108:111], v6, s[32:35], s41 offen offset:3712 nt
    s_setprio 3
    s_waitcnt lgkmcnt(0)
    v_readfirstlane_b32 s53, v27
    s_cmp_eq_u32 s40, 2
    s_cbranch_scc1 L_nocnt_54
    s_waitcnt vmcnt(2)
    v_mov_b32 v5, 1
    s_mov_b64 exec, 1
    ds_add_u32 v3, v5 offset:36
    s_mov_b64 exec, -1
L_nocnt_54:
    s_mov_b32 s78, 400000
L_mpoll:
    ds_read_b32 v24, v4
    ds_read_b128 v[20:23], v7
    s_waitcnt lgkmcnt(0)
    v_max3_u32 v5, v20, v21, v22
    v_max3_u32 v5, v5, v23, v24
    v_cmp_eq_u32 vcc, -1, v5
    v_and_b32 v56, v24, v60
    v_and_b32 v57, v24, v61
    v_and_b32 v58, v24, v62
    v_and_b32 v59, v24, v63
    s_cbranch_vccz L_ok_55
    s_sub_u32 s78, s78, 1
    s_cbranch_scc0 L_mpoll
L_ok_55:
    v_and_b32 v40, v20, v60
    v_and_b32 v41, v20, v61
    s_waitcnt vmcnt(14)
    v_mfma_f32_16x16x32_bf16 v[28:31], v[56:59], v[112:115], 0
    v_and_b32 v42, v20, v62
    v_and_b32 v43, v20, v63
    s_waitcnt vmcnt(13)
    v_mfma_f32_16x16x32_bf16 v[32:35], v[56:59], v[116:119], 0
    s_waitcnt vmcnt(12)
    v_mfma_f32_16x16x32_bf16 v[36:39], v[56:59], v[120:123], 0
    v_and_b32 v44, v21, v60
    v_and_b32 v45, v21, v61
    s_waitcnt vmcnt(11)
    v_mfma_f32_16x16x32_bf16 v[28:31], v[40:43], v[64:67], v[28:31]
    v_and_b32 v46, v21, v62
    v_and_b32 v47, v21, v63
    s_waitcnt vmcnt(10)
    v_mfma_f32_16x16x32_bf16 v[32:35], v[40:43], v[68:71], v[32:35]
    s_waitcnt vmcnt(9)
    v_mfma_f32_16x16x32_bf16 v[36:39], v[40:43], v[72:75], v[36:39]
    v_and_b32 v48, v22, v60
    v_and_b32 v49, v22, v61
    s_waitcnt vmcnt(8)
    v_mfma_f32_16x16x32_bf16 v[28:31], v[44:47], v[76:79], v[28:31]
    v_and_b32 v50, v22, v62
    v_and_b32 v51, v22, v63
    s_waitcnt vmcnt(7)
    v_mfma_f32_16x16x32_bf16 v[32:35], v[44:47], v[80:83], v[32:35]
    s_waitcnt vmcnt(6)
    v_mfma_f32_16x16x32_bf16 v[36:39], v[44:47], v[84:87], v[36:39]
    v_and_b32 v52, v23, v60
    v_and_b32 v53, v23, v61
    s_waitcnt vmcnt(5)
    v_mfma_f32_16x16x32_bf16 v[28:31], v[48:51], v[88:91], v[28:31]
    v_and_b32 v54, v23, v62
    v_and_b32 v55, v23, v63
    s_waitcnt vmcnt(4)
    v_mfma_f32_16x16x32_bf16 v[32:35], v[48:51], v[92:95], v[32:35]
    s_waitcnt vmcnt(3)
    v_mfma_f32_16x16x32_bf16 v[36:39], v[48:51], v[96:99], v[36:39]
    s_waitcnt vmcnt(2)
    v_mfma_f32_16x16x32_bf16 v[28:31], v[52:55], v[100:103], v[28:31]
    s_waitcnt vmcnt(1)
    v_mfma_f32_16x16x32_bf16 v[32:35], v[52:55], v[104:107], v[32:35]
    s_waitcnt vmcnt(0)
    v_mfma_f32_16x16x32_bf16 v[36:39], v[52:55], v[108:111], v[36:39]
    s_nop 3
    v_permlane32_swap_b32 v28, v30
    v_permlane32_swap_b32 v29, v31
    v_permlane32_swap_b32 v32, v34
    v_permlane32_swap_b32 v33, v35
    v_permlane32_swap_b32 v36, v38
    v_permlane32_swap_b32 v37, v39
    v_add_f32_dpp v8, v30, v28 row_ror:8 row_mask:0xf bank_mask:0xf
    v_add_f32_dpp v9, v31, v29 row_ror:8 row_mask:0xf bank_mask:0xf
    v_add_f32_dpp v10, v34, v32 row_ror:8 row_mask:0xf bank_mask:0xf
    v_add_f32_dpp v11, v35, v33 row_ror:8 row_mask:0xf bank_mask:0xf
    v_add_f32_dpp v12, v38, v36 row_ror:8 row_mask:0xf bank_mask:0xf
    v_add_f32_dpp v13, v39, v37 row_ror:8 row_mask:0xf bank_mask:0xf
    v_cvt_pk_bf16_f32 v8, v8, v9
    v_cvt_pk_bf16_f32 v9, v10, v11
    v_cvt_pk_bf16_f32 v10, v12, v13
    s_mov_b32 exec_lo, 0x00ff00ff
    s_mov_b32 exec_hi, 0x00ff00ff
    s_cmp_eq_u32 s53, 1
    s_cbranch_scc0 L_ms_56
    buffer_store_dword v8, v26, s[36:39], s50 offen offset:1792
    buffer_store_dword v9, v26, s[36:39], s50 offen offset:1920
    buffer_store_dword v10, v26, s[36:39], s50 offen offset:2048
L_me_57:
    s_mov_b64 exec, 1
    v_mov_b32 v5, 1
    ds_add_u32 v3, v5 offset:24
    s_endpgm
L_ms_42:
    buffer_store_dword v24, v7, s[36:39], s45 offen offset:1152 sc1
    s_branch L_me_43
L_ms_56:
    buffer_store_dword v8, v26, s[36:39], s50 offen offset:1792 sc1
    buffer_store_dword v9, v26, s[36:39], s50 offen offset:1920 sc1
    buffer_store_dword v10, v26, s[36:39], s50 offen offset:2048 sc1
    s_branch L_me_57
L_red:
    s_lshr_b32 s55, s2, 3
    s_and_b32 s56, s2, 7
    s_mov_b32 s77, 40000
    s_cmp_eq_u32 s40, 1
    s_cbranch_scc1 L_final
    s_sub_u32 s55, s55, 14
    s_cbranch_scc1 L_Rdone
    s_cmp_ge_u32 s55, 9
    s_cselect_b32 s58, 1, 0
    s_mul_i32 s59, s58, 9
    s_sub_u32 s59, s55, s59
    s_mul_i32 s57, s58, 23552
    s_add_u32 s57, s57, s75
    s_lshl_b32 s62, s59, 7
    s_add_u32 s57, s57, s62
    s_add_u32 s62, s57, 47104
    v_mul_u32_u24 v8, 2944, v2
    v_lshl_add_u32 v8, v1, 4, v8
    s_lshr_b32 s63, s59, 1
    s_lshl_b32 s63, s63, 14
    s_and_b32 s59, s59, 1
    s_lshl_b32 s59, s59, 12
    s_add_u32 s59, s59, s63
    s_lshl_b32 s58, s58, 7
    s_add_u32 s59, s59, s58
    s_lshl_b32 s58, s56, 8
    s_add_u32 s59, s59, s58
    s_add_u32 s59, s59, 753664
    v_lshlrev_b32 v9, 5, v1
    v_bfe_u32 v10, v0, 4, 1
    v_lshl_add_u32 v9, v10, 4, v9
    v_lshrrev_b32 v10, 5, v0
    v_lshl_add_u32 v9, v10, 3, v9
    v_lshrrev_b32 v10, 7, v9
    v_and_b32 v9, 127, v9
    v_lshl_add_u32 v9, v10, 11, v9
    v_lshrrev_b32 v44, 5, v0
    v_mul_u32_u24 v44, 0x6a, v44
    v_mov_b32 v46, 0xff
    s_add_u32 s63, s59, 0x2000
    v_and_b32 v20, 1, v1
    v_lshlrev_b32 v20, 4, v20
    v_mov_b32 v21, 0xffff
    v_lshlrev_b32 v20, v20, v21
    v_lshrrev_b32 v21, 1, v1
    v_cmp_eq_u32 vcc, 0, v21
    s_nop 1
    v_cndmask_b32 v16, 0, v20, vcc
    v_cmp_eq_u32 vcc, 1, v21
    s_nop 1
    v_cndmask_b32 v17, 0, v20, vcc
    v_cmp_eq_u32 vcc, 2, v21
    s_nop 1
    v_cndmask_b32 v18, 0, v20, vcc
    v_cmp_eq_u32 vcc, 3, v21
    s_nop 1
    v_cndmask_b32 v19, 0, v20, vcc
    v_and_b32 v16, 0x3f803f80, v16
    v_and_b32 v17, 0x3f803f80, v17
    v_and_b32 v18, 0x3f803f80, v18
    v_and_b32 v19, 0x3f803f80, v19
    s_mov_b32 s78, 400000
L_sp_58:
    ds_read_b32 v14, v3 offset:24
    s_waitcnt lgkmcnt(0)
    v_readfirstlane_b32 s79, v14
    s_cmp_ge_u32 s79, 1
    s_cbranch_scc1 L_spd_59
    s_sleep 1
    s_sub_u32 s78, s78, 1
    s_cbranch_scc0 L_sp_58
L_spd_59:
    ds_read_b32 v41, v3 offset:40
    buffer_load_dwordx4 v[64:67], v8, s[48:51], s57 offen offset:1792 sc1
    buffer_load_dwordx4 v[68:71], v8, s[48:51], s62 offen offset:1792 sc1
    buffer_load_dwordx4 v[72:75], v8, s[48:51], s57 offen offset:1792 sc1
    buffer_load_dwordx4 v[76:79], v8, s[48:51], s62 offen offset:1792 sc1
    s_waitcnt lgkmcnt(0)
    v_add_u32 v44, v44, v41
    v_add_u32 v45, 0x35, v44
L_rpoll:
    buffer_load_dwordx4 v[80:83], v8, s[48:51], s57 offen offset:1792 sc1
    buffer_load_dwordx4 v[84:87], v8, s[48:51], s62 offen offset:1792 sc1
    s_waitcnt vmcnt(4)
    v_mfma_f32_16x16x32_bf16 v[32:35], v[16:19], v[64:67], 0
    v_mfma_f32_16x16x32_bf16 v[32:35], v[16:19], v[68:71], v[32:35]
    v_max3_u32 v14, v64, v65, v66
    v_max3_u32 v14, v14, v67, v68
    v_max3_u32 v14, v14, v69, v70
    v_max_u32 v14, v14, v71
    v_cmp_eq_u32 vcc, -1, v14
    s_cbranch_vccz L_rok
    buffer_load_dwordx4 v[64:67], v8, s[48:51], s57 offen offset:1792 sc1
    buffer_load_dwordx4 v[68:71], v8, s[48:51], s62 offen offset:1792 sc1
    s_waitcnt vmcnt(4)
    v_mfma_f32_16x16x32_bf16 v[32:35], v[16:19], v[72:75], 0
    v_mfma_f32_16x16x32_bf16 v[32:35], v[16:19], v[76:79], v[32:35]
    v_max3_u32 v14, v72, v73, v74
    v_max3_u32 v14, v14, v75, v76
    v_max3_u32 v14, v14, v77, v78
    v_max_u32 v14, v14, v79
    v_cmp_eq_u32 vcc, -1, v14
    s_cbranch_vccz L_rok
    buffer_load_dwordx4 v[72:75], v8, s[48:51], s57 offen offset:1792 sc1
    buffer_load_dwordx4 v[76:79], v8, s[48:51], s62 offen offset:1792 sc1
    s_waitcnt vmcnt(4)
    v_mfma_f32_16x16x32_bf16 v[32:35], v[16:19], v[80:83], 0
    v_mfma_f32_16x16x32_bf16 v[32:35], v[16:19], v[84:87], v[32:35]
    v_max3_u32 v14, v80, v81, v82
    v_max3_u32 v14, v14, v83, v84
    v_max3_u32 v14, v14, v85, v86
    v_max_u32 v14, v14, v87
    v_cmp_eq_u32 vcc, -1, v14
    s_cbranch_vccz L_rok
    s_sub_u32 s77, s77, 1
    s_cbranch_scc0 L_rpoll
L_rok:
    s_nop 1
    v_permlane32_swap_b32 v32, v34
    v_permlane32_swap_b32 v33, v35
    s_nop 0
    v_add_f32_dpp v40, v34, v32 row_ror:8 row_mask:0xf bank_mask:0xf
    v_add_f32_dpp v41, v35, v33 row_ror:8 row_mask:0xf bank_mask:0xf
    v_bfi_b32 v40, v46, v44, v40
    v_bfi_b32 v41, v46, v45, v41
    s_mov_b32 exec_lo, 0x00ff00ff
    s_mov_b32 exec_hi, 0x00ff00ff
    buffer_store_dwordx2 v[40:41], v9, s[48:51], s59 offen sc1
    buffer_store_dwordx2 v[40:41], v9, s[48:51], s63 offen sc1
L_Rdone:
    s_endpgm
L_final:
    s_cmp_ge_u32 s2, 18
    s_cbranch_scc1 L_Rdone
    s_mov_b64 s[32:33], s[4:5]
    s_mov_b32 s34, 1152
    s_mov_b32 s35, 0x20000
    s_mov_b64 s[36:37], s[22:23]
    s_mov_b32 s38, 1152
    s_mov_b32 s39, 0x20000
    v_lshl_add_u32 v9, v1, 2, v4
    v_lshlrev_b32 v9, 1, v9
    s_lshl_b32 s56, s2, 6
    buffer_load_ushort v10, v9, s[32:35], s56 offen
    v_lshlrev_b32 v8, 4, v0
    s_mov_b32 s78, 400000
L_sp_60:
    ds_read_b32 v14, v3 offset:8
    s_waitcnt lgkmcnt(0)
    v_readfirstlane_b32 s79, v14
    s_cmp_ge_u32 s79, 1
    s_cbranch_scc1 L_spd_61
    s_sleep 1
    s_sub_u32 s78, s78, 1
    s_cbranch_scc0 L_sp_60
L_spd_61:
    ds_read_b32 v14, v3 offset:52
    s_lshr_b32 s57, s2, 2
    s_lshl_b32 s57, s57, 14
    s_and_b32 s58, s2, 3
    s_lshl_b32 s58, s58, 11
    s_add_u32 s57, s57, s58
    s_waitcnt lgkmcnt(0)
    v_readfirstlane_b32 s58, v14
    s_add_u32 s57, s57, 753664
    s_and_b32 s58, s58, 0x2000
    s_add_u32 s57, s57, s58
    buffer_load_dwordx4 v[64:67], v8, s[48:51], s57 offen offset:0 sc1
    buffer_load_dwordx4 v[68:71], v8, s[48:51], s57 offen offset:1024 sc1
    s_mov_b32 s78, 400000
L_sp_62:
    ds_read_b32 v14, v3 offset:24
    s_waitcnt lgkmcnt(0)
    v_readfirstlane_b32 s79, v14
    s_cmp_ge_u32 s79, 3
    s_cbranch_scc1 L_spd_63
    s_sleep 1
    s_sub_u32 s78, s78, 1
    s_cbranch_scc0 L_sp_62
L_spd_63:
    ds_read_b32 v15, v3 offset:40
    s_waitcnt vmcnt(0) lgkmcnt(0)
    v_readfirstlane_b32 s60, v15
    v_lshlrev_b32 v10, 16, v10
    buffer_load_dwordx4 v[64:67], v8, s[48:51], s57 offen offset:0 sc1
    buffer_load_dwordx4 v[68:71], v8, s[48:51], s57 offen offset:1024 sc1
    buffer_load_dwordx4 v[72:75], v8, s[48:51], s57 offen offset:0 sc1
    buffer_load_dwordx4 v[76:79], v8, s[48:51], s57 offen offset:1024 sc1
    s_mov_b32 s64, s60
    s_add_u32 s65, s60, 53
    s_add_u32 s66, s60, 106
    s_add_u32 s67, s60, 159
    s_movk_i32 s43, 0xff00
L_fpoll:
    buffer_load_dwordx4 v[80:83], v8, s[48:51], s57 offen offset:0 sc1
    buffer_load_dwordx4 v[84:87], v8, s[48:51], s57 offen offset:1024 sc1
    s_waitcnt vmcnt(4)
    v_bitop3_b32 v20, v64, v68, s64 bitop3:0x7e
    v_bitop3_b32 v21, v65, v69, s65 bitop3:0x7e
    v_bitop3_b32 v22, v66, v70, s66 bitop3:0x7e
    v_bitop3_b32 v23, v67, v71, s67 bitop3:0x7e
    v_or3_b32 v20, v20, v21, v22
    v_bitop3_b32 v20, v20, v23, s43 bitop3:0x54
    v_cmp_ne_u32 vcc, 0, v20
    v_and_b32 v24, s43, v64
    v_and_b32 v25, s43, v65
    v_and_b32 v26, s43, v66
    v_and_b32 v27, s43, v67
    v_and_b32 v28, s43, v68
    v_and_b32 v29, s43, v69
    v_and_b32 v30, s43, v70
    v_and_b32 v31, s43, v71
    s_cbranch_vccz L_fok
    buffer_load_dwordx4 v[64:67], v8, s[48:51], s57 offen offset:0 sc1
    buffer_load_dwordx4 v[68:71], v8, s[48:51], s57 offen offset:1024 sc1
    s_waitcnt vmcnt(4)
    v_bitop3_b32 v20, v72, v76, s64 bitop3:0x7e
    v_bitop3_b32 v21, v73, v77, s65 bitop3:0x7e
    v_bitop3_b32 v22, v74, v78, s66 bitop3:0x7e
    v_bitop3_b32 v23, v75, v79, s67 bitop3:0x7e
    v_or3_b32 v20, v20, v21, v22
    v_bitop3_b32 v20, v20, v23, s43 bitop3:0x54
    v_cmp_ne_u32 vcc, 0, v20
    v_and_b32 v24, s43, v72
    v_and_b32 v25, s43, v73
    v_and_b32 v26, s43, v74
    v_and_b32 v27, s43, v75
    v_and_b32 v28, s43, v76
    v_and_b32 v29, s43, v77
    v_and_b32 v30, s43, v78
    v_and_b32 v31, s43, v79
    s_cbranch_vccz L_fok
    buffer_load_dwordx4 v[72:75], v8, s[48:51], s57 offen offset:0 sc1
    buffer_load_dwordx4 v[76:79], v8, s[48:51], s57 offen offset:1024 sc1
    s_waitcnt vmcnt(4)
    v_bitop3_b32 v20, v80, v84, s64 bitop3:0x7e
    v_bitop3_b32 v21, v81, v85, s65 bitop3:0x7e
    v_bitop3_b32 v22, v82, v86, s66 bitop3:0x7e
    v_bitop3_b32 v23, v83, v87, s67 bitop3:0x7e
    v_or3_b32 v20, v20, v21, v22
    v_bitop3_b32 v20, v20, v23, s43 bitop3:0x54
    v_cmp_ne_u32 vcc, 0, v20
    v_and_b32 v24, s43, v80
    v_and_b32 v25, s43, v81
    v_and_b32 v26, s43, v82
    v_and_b32 v27, s43, v83
    v_and_b32 v28, s43, v84
    v_and_b32 v29, s43, v85
    v_and_b32 v30, s43, v86
    v_and_b32 v31, s43, v87
    s_cbranch_vccz L_fok
    s_sub_u32 s77, s77, 1
    s_cbranch_scc0 L_fpoll
L_fok:
    v_pk_add_f32 v[24:25], v[24:25], v[28:29]
    v_pk_add_f32 v[26:27], v[26:27], v[30:31]
    s_nop 1
    v_permlane32_swap_b32 v24, v26
    v_permlane32_swap_b32 v25, v27
    v_pk_add_f32 v[24:25], v[24:25], v[26:27]
    s_nop 1
    v_permlane16_swap_b32 v24, v25
    v_add_f32 v16, v24, v25
    v_cvt_pk_bf16_f32 v16, v16, v16
    v_and_b32 v16, 0xffff0000, v16
    s_nop 1
    v_mov_b32_dpp v17, v16 row_ror:8 row_mask:0xf bank_mask:0xf
    v_mul_f32 v18, 0xbfb8aa3b, v17
    v_exp_f32 v18, v18
    s_nop 0
    v_add_f32 v18, 1.0, v18
    v_rcp_f32 v18, v18
    s_nop 0
    v_mul_f32 v18, v17, v18
    v_cvt_pk_bf16_f32 v18, v18, v18
    v_and_b32 v18, 0xffff0000, v18
    v_mul_f32 v18, v16, v18
    v_cvt_pk_bf16_f32 v18, v18, v18
    v_and_b32 v18, 0xffff0000, v18
    v_add_f32 v18, v10, v18
    v_cvt_pk_bf16_f32 v18, v18, v18
    s_mov_b32 exec_lo, 0x00ff00ff
    s_mov_b32 exec_hi, 0x00ff00ff
    buffer_store_short v18, v9, s[36:39], s56 offen
    s_cmp_lg_u32 s2, 0
    s_cbranch_scc1 L_Rdone
    s_mov_b32 s56, 901120
    s_mov_b64 exec, 1
    buffer_store_dword v15, v9, s[48:51], s56 offen
    s_endpgm
L_end:
    s_endpgm

.section .rodata,"a"
.p2align 6
.amdhsa_kernel recurrent_scan__sliding_block_cached__glu_gated_swiglu__decode_kernel
  .amdhsa_next_free_vgpr 128
  .amdhsa_next_free_sgpr 102
  .amdhsa_accum_offset 128
  .amdhsa_group_segment_fixed_size 0
  .amdhsa_kernarg_size 96
  .amdhsa_user_sgpr_count 2
  .amdhsa_user_sgpr_kernarg_segment_ptr 1
  .amdhsa_system_sgpr_workgroup_id_x 1
  .amdhsa_float_denorm_mode_32 3
.end_amdhsa_kernel
```
